```python
import torch

def _softmax(x, axis=-1):
    return torch.softmax(x, dim=axis)
def _gelu(x):
    return torch.nn.functional.gelu(x, approximate="tanh")
def _silu(x):
    return torch.nn.functional.silu(x)
def _sigmoid(x):
    return torch.sigmoid(x)
def _layernorm(x, axis=-1, eps=1e-5):
    m = x.mean(dim=axis, keepdim=True)
    v = x.var(dim=axis, keepdim=True, unbiased=False)
    return (x - m) / torch.sqrt(v + eps)
def _scatter_add(tgt, idx, src, axis=0):
    return tgt.clone().index_add_(axis, idx, src)
def _segment_sum(src, seg, n):
    out = torch.zeros((n,) + src.shape[1:], dtype=src.dtype)
    return out.index_add_(0, seg, src)
def _pad(x, pw):
    flat = tuple(v for pair in reversed(pw) for v in pair)
    return torch.nn.functional.pad(x, flat)

kernel_name = 'parallel_sum__grouped_kv_mqa__glu_gated_geglu__prompt'

def setup_inputs():

    _w = (lambda a: (lambda t: t.to(torch.bfloat16) if t.is_floating_point() else t)(torch.as_tensor(a)))
    def _A_setup():
        B, S, D, H = 1, 2048, 448, 16
        Dh = D // H
        return {
            "x": _w((lambda *s: torch.randn(*s, dtype=torch.bfloat16) * 0.05)(B, S, D)),
            "wq": _w((lambda *s: torch.randn(*s, dtype=torch.bfloat16) * 0.05)(D, H * Dh)),
            "wk": _w((lambda *s: torch.randn(*s, dtype=torch.bfloat16) * 0.05)(D, Dh)),
            "wv": _w((lambda *s: torch.randn(*s, dtype=torch.bfloat16) * 0.05)(D, Dh)),
            "wo": _w((lambda *s: torch.randn(*s, dtype=torch.bfloat16) * 0.05)(H * Dh, D)),
        }
    _A_in = _A_setup()

    def _B_setup():
        B, S, Dm, Df = 1, 2048, 448, 1792
        return {
            "x": _w((lambda *s: torch.randn(*s, dtype=torch.bfloat16) * 0.05)(B, S, Dm)),
            "w_gate": _w((lambda *s: torch.randn(*s, dtype=torch.bfloat16) * 0.4)(Dm, Df) * (Dm ** -0.5)),
            "w_up": _w((lambda *s: torch.randn(*s, dtype=torch.bfloat16) * 0.4)(Dm, Df) * (Dm ** -0.5)),
            "w_down": _w((lambda *s: torch.randn(*s, dtype=torch.bfloat16) * 0.4)(Df, Dm) * (Df ** -0.5)),
        }
    _B_in = _B_setup()

    return {
        "A_x": _A_in["x"],
        "A_wq": _A_in["wq"],
        "A_wk": _A_in["wk"],
        "A_wv": _A_in["wv"],
        "A_wo": _A_in["wo"],
        "B_x": _B_in["x"],
        "B_w_gate": _B_in["w_gate"],
        "B_w_up": _B_in["w_up"],
        "B_w_down": _B_in["w_down"],
    }

def reference(A_x, A_wq, A_wk, A_wv, A_wo, B_x, B_w_gate, B_w_up, B_w_down):
    def _A_ref(x, wq, wk, wv, wo):
        B, S, D = x.shape
        H = 16
        Dh = D // H
        q = (lambda x, *d: x.permute(*d))((x @ wq).reshape(B, S, H, Dh), 0, 2, 1, 3)
        k = x @ wk
        v = x @ wv
        scores = torch.einsum("bhqd,bkd->bhqk", q, k) * (Dh ** -0.5)
        p = _softmax(scores, axis=-1)
        o = torch.einsum("bhqk,bkd->bhqd", p, v)
        return (lambda x, *d: x.permute(*d))(o, 0, 2, 1, 3).reshape(B, S, H * Dh) @ wo

    def _B_ref(x, w_gate, w_up, w_down):
        g = torch.einsum("bsd,df->bsf", x, w_gate)
        u = torch.einsum("bsd,df->bsf", x, w_up)
        h = _gelu(g) * u
        return torch.einsum("bsf,fd->bsd", h, w_down)

    x = A_x
    xn = _layernorm(x, axis=-1)
    return x + _A_ref(xn, A_wq, A_wk, A_wv, A_wo) + _B_ref(xn, B_w_gate, B_w_up, B_w_down)
```

```asm
; @launch grid=(256,1,1) block=(512,1,1) lds=151808
.amdgcn_target "amdgcn-amd-amdhsa--gfx950"
.text
.globl parallel_sum__grouped_kv_mqa__glu_gated_geglu__prompt_kernel
.p2align 8
.type parallel_sum__grouped_kv_mqa__glu_gated_geglu__prompt_kernel,@function
parallel_sum__grouped_kv_mqa__glu_gated_geglu__prompt_kernel:
    s_cmp_ge_u32 s2, 256
    s_cbranch_scc1 K_end
    s_load_dwordx16 s[8:23], s[0:1], 0
    s_load_dwordx8 s[24:31], s[0:1], 64
    s_getpc_b64 s[44:45]
K_pc:
    s_mov_b32 s46, K_end-K_pc
    s_mov_b32 s47, 0x00020000
    s_lshr_b32 s6, s2, 3
    s_lshl_b32 s6, s6, 11
    v_lshrrev_b32 v1, 5, v0
    v_lshl_add_u32 v1, v1, 7, s6
    buffer_load_dword v100, v1, s[44:47], 0 offen
    v_lshrrev_b32 v1, 6, v0
    v_and_b32 v0, 63, v0
    v_readfirstlane_b32 s3, v1
    s_nop 1
    s_lshl_b32 s61, s2, 3
    s_add_u32 s61, s61, s3
    s_mul_i32 s6, s61, 896
    v_lshl_add_u32 v99, v0, 4, s6
    v_cmp_lt_u32 vcc, 55, v0
    v_mov_b32 v101, 2147483632
    s_nop 0
    v_cndmask_b32 v99, v99, v101, vcc
    s_bfe_u32 s4, s2, 0x20001
    s_lshl_b32 s4, s4, 2
    s_lshr_b32 s6, s2, 6
    s_add_u32 s4, s4, s6
    s_and_b32 s5, s2, 1
    s_lshl_b32 s5, s5, 3
    s_bfe_u32 s7, s2, 0x30003
    s_add_u32 s5, s5, s7
    s_lshr_b32 s62, s5, 2
    s_sub_u32 s59, s5, s62
    s_lshl_b32 s48, s3, 10
    s_lshl_b32 s68, s59, 7
    s_mul_i32 s70, s62, 224
    s_and_b32 s71, s62, 1
    s_sub_u32 s72, 4, s71
    s_lshl_b32 s71, s71, 5
    s_movk_i32 s69, 3584
    s_and_b32 s63, s5, 3
    s_cmp_eq_u32 s63, 3
    s_cselect_b32 s63, 1, 0
    s_cselect_b32 s66, 14, 8
    s_cselect_b32 s67, 896, s69
    s_cselect_b32 s69, 56, s69
    s_cselect_b32 s73, s71, s68
    s_cselect_b32 s68, s70, s68
    s_cselect_b32 s72, s72, 4
    s_add_u32 s75, s63, 1
    s_lshl_b32 s70, s4, 7
    s_lshl_b32 s71, s3, 3
    s_add_u32 s71, s71, s70
    v_lshrrev_b32 v60, 3, v0
    v_add_u32 v60, s71, v60
    v_mul_u32_u24 v60, 896, v60
    s_lshl_b32 s71, s3, 2
    v_lshrrev_b32 v61, 4, v0
    v_add_u32 v62, s71, v61
    v_xor_b32 v63, v62, v0
    v_and_b32 v63, 7, v63
    v_lshl_add_u32 v3, v63, 4, v60
    s_mov_b32 s47, 0
    v_lshlrev_b32 v61, s75, v61
    v_xor_b32 v61, v61, v0
    v_and_b32 v61, 15, v61
    v_cmp_le_u32 vcc, s66, v61
    v_mul_lo_u32 v240, v62, s67
    v_lshl_add_u32 v240, v61, 4, v240
    v_add_u32 v240, s68, v240
    v_subrev_u32 v61, s66, v61
    v_lshlrev_b32 v61, s72, v61
    v_mul_lo_u32 v60, v62, s69
    v_add3_u32 v60, v60, v61, s73
    v_cndmask_b32 v240, v240, v60, vcc
    v_mov_b32 v6, s67
    v_mov_b32 v60, s69
    v_cndmask_b32 v6, v6, v60, vcc
    v_lshlrev_b32 v6, 5, v6
    s_mov_b64 s[64:65], vcc
    s_waitcnt lgkmcnt(0)
    s_mov_b32 s32, s8
    s_mov_b32 s33, s9
    s_mov_b32 s34, 1835008
    s_mov_b32 s35, 0x00020000
    buffer_load_dwordx4 v[104:107], v99, s[32:35], 0 offen
    s_add_u32 m0, s48, 0
    s_mov_b32 s50, 0
    buffer_load_dwordx4 v3, s[32:35], s50 offen  lds
    s_add_u32 m0, s48, 8192
    s_mov_b32 s50, 57344
    buffer_load_dwordx4 v3, s[32:35], s50 offen  lds
    s_cmp_lt_u32 s62, 2
    s_cselect_b32 s68, s12, s14
    s_cselect_b32 s69, s13, s15
    s_cmp_eq_u32 s63, 1
    s_cselect_b32 s66, s10, s20
    s_cselect_b32 s67, s11, s21
    s_cselect_b32 s68, s68, s22
    s_cselect_b32 s69, s69, s23
    v_mov_b32 v60, s66
    v_mov_b32 v61, s67
    v_mov_b32 v62, s68
    v_mov_b32 v63, s69
    v_cndmask_b32 v4, v60, v62, s[64:65]
    v_cndmask_b32 v5, v61, v63, s[64:65]
    v_add_co_u32 v4, vcc, v4, v240
    v_mov_b32 v7, 0
    s_nop 0
    v_addc_co_u32 v5, vcc, 0, v5, vcc
    s_add_u32 m0, s48, 16384
    s_nop 0
    global_load_lds_dwordx4 v[4:5], off
    s_add_u32 m0, s48, 24576
    v_lshl_add_u64 v[4:5], v[6:7], 0, v[4:5]
    global_load_lds_dwordx4 v[4:5], off
    s_min_u32 s6, s61, 1393
    s_cmp_ge_u32 s6, 448
    s_cselect_b32 s40, s22, s20
    s_cselect_b32 s41, s23, s21
    s_cselect_b32 s66, 448, 0
    s_mov_b32 s69, 1605632
    s_cmp_ge_u32 s6, 896
    s_cselect_b32 s40, s10, s40
    s_cselect_b32 s41, s11, s41
    s_cselect_b32 s66, 896, s66
    s_cselect_b32 s67, 6, 11
    s_cselect_b32 s68, 7, 28
    s_cselect_b32 s69, 401408, s69
    s_cmp_ge_u32 s6, 1344
    s_cselect_b32 s40, s12, s40
    s_cselect_b32 s41, s13, s41
    s_cselect_b32 s66, 1344, s66
    s_cselect_b32 s67, 7, s67
    s_cselect_b32 s68, 8, s68
    s_cselect_b32 s42, 25088, s69
    s_cmp_ge_u32 s6, 1369
    s_cselect_b32 s40, s14, s40
    s_cselect_b32 s41, s15, s41
    s_cselect_b32 s66, 1369, s66
    s_mov_b32 s43, 0x00020000
    s_sub_u32 s6, s6, s66
    s_mul_i32 s6, s6, s68
    v_min_u32 v96, s67, v0
    v_add_u32 v96, s6, v96
    v_lshlrev_b32 v96, 7, v96
    buffer_load_dword v100, v96, s[40:43], 0 offen
    s_mov_b32 s6, 13867008
    s_load_dword s58, s[30:31], s6
    s_and_b32 s52, s3, 3
    s_lshr_b32 s53, s3, 2
    s_lshl_b32 s55, s53, 1
    s_add_u32 s56, s55, 1
    s_xor_b32 s66, s52, s53
    s_mov_b32 s49, 0xffff0000
    s_mov_b32 s64, 0
    s_mov_b32 s65, -1
    v_lshlrev_b32 v1, 4, v0
    v_and_b32 v60, 31, v0
    v_lshrrev_b32 v61, 5, v0
    v_bfe_u32 v62, v0, 1, 3
    v_xor_b32 v62, v62, v61
    v_lshlrev_b32 v62, 4, v62
    v_lshl_add_u32 v62, v60, 7, v62
    s_lshl_b32 s6, s52, 12
    s_lshl_b32 s67, s66, 5
    s_or_b32 s6, s6, s67
    v_xor_b32 v8, s6, v62
    v_xor_b32 v9, 32, v8
    v_xor_b32 v10, 64, v8
    v_xor_b32 v11, 96, v8
    v_bfe_u32 v241, v0, 2, 2
    v_lshl_add_u32 v250, v61, 3, v241
    v_lshlrev_b32 v250, 8, v250
    s_lshl_b32 s66, s66, 12
    v_add_u32 v250, s66, v250
    s_cmp_eq_u32 s63, 1
    s_cselect_b32 s66, 56, 32
    s_cselect_b32 s67, 5, 7
    s_cselect_b32 s68, 0x88880000, 0
    s_mov_b32 s69, s68
    s_add_u32 s6, s75, 4
    v_bfe_u32 v60, v0, 4, 1
    v_and_b32 v61, 3, v0
    v_lshlrev_b32 v60, s67, v60
    v_lshl_add_u32 v60, v61, 3, v60
    v_lshlrev_b32 v61, s6, v241
    s_mul_i32 s6, s55, s66
    s_lshl_b32 s7, s55, 3
    s_sub_u32 s7, 248, s7
    v_add_u32 v62, s6, v60
    v_mov_b32 v63, s7
    v_cndmask_b32 v62, v62, v63, s[68:69]
    v_xor_b32 v62, v62, v61
    v_add_u32 v12, v62, v250
    s_mul_i32 s6, s56, s66
    s_lshl_b32 s7, s56, 3
    s_sub_u32 s7, 248, s7
    v_add_u32 v62, s6, v60
    v_mov_b32 v63, s7
    v_cndmask_b32 v62, v62, v63, s[68:69]
    v_xor_b32 v62, v62, v61
    v_add_u32 v16, v62, v250
    v_xor_b32 v13, 4096, v12
    v_xor_b32 v14, 8192, v12
    v_xor_b32 v15, 12288, v12
    v_xor_b32 v17, 4096, v16
    v_xor_b32 v18, 8192, v16
    v_xor_b32 v19, 12288, v16
    v_bfe_u32 v60, v0, 4, 1
    v_and_b32 v61, 15, v0
    v_cmp_eq_u32 vcc, v60, v61
    v_mov_b32 v60, 0x3f803f80
    s_nop 0
    v_cndmask_b32 v24, 0, v60, vcc
    v_mov_b32 v25, v24
    v_mov_b32 v26, v24
    v_mov_b32 v27, v24
    s_lshl_b32 s45, s61, 3
    s_add_u32 s45, s45, 13905920
    s_add_u32 s60, s59, 12
    s_add_u32 s6, s62, 24
    s_cmp_eq_u32 s63, 1
    s_cselect_b32 s60, s6, s60
    v_lshrrev_b32 v248, 4, v0
    s_lshl_b32 s6, s47, 4
    s_add_u32 s6, s6, s3
    s_lshl_b32 s6, s6, 2
    v_add_u32 v249, s6, v248
    v_mul_u32_u24 v249, 3584, v249
    v_lshlrev_b32 v248, 1, v248
    v_xor_b32 v248, v248, v0
    v_and_b32 v102, 7, v248
    v_lshl_add_u32 v249, v102, 4, v249
    s_lshl_b32 s6, s60, 7
    v_add_u32 v249, s6, v249
    v_and_b32 v248, 8, v248
    v_cmp_eq_u32 vcc, 8, v248
    v_mov_b32 v102, s20
    v_mov_b32 v248, s22
    v_cndmask_b32 v102, v102, v248, vcc
    v_mov_b32 v103, s21
    v_mov_b32 v248, s23
    v_cndmask_b32 v103, v103, v248, vcc
    v_add_co_u32 v102, vcc, v102, v249
    v_bfe_u32 v248, v0, 4, 1
    v_and_b32 v249, 3, v0
    v_addc_co_u32 v103, vcc, 0, v103, vcc
    v_lshlrev_b32 v249, 3, v249
    v_lshl_add_u32 v248, v248, 7, v249
    v_bfe_u32 v249, v0, 2, 2
    v_lshlrev_b32 v249, 5, v249
    v_xor_b32 v248, v248, v249
    s_lshl_b32 s6, s55, 5
    v_xor_b32 v248, s6, v248
    v_add_u32 v250, v248, v250
    v_xor_b32 v251, 32, v250
    s_mul_i32 s6, s4, 12
    s_add_u32 s6, s6, s59
    s_lshl_b32 s7, s4, 2
    s_add_u32 s7, s7, s62
    s_min_u32 s7, s7, 59
    s_add_u32 s66, s7, 136
    s_cmp_eq_u32 s63, 1
    s_cselect_b32 s6, s66, s6
    s_cselect_b32 s7, s7, 63
    s_mul_hi_u32 s66, s6, 153391690
    s_mul_i32 s67, s66, 28
    s_sub_u32 s67, s6, s67
    s_lshr_b32 s68, s7, 3
    s_and_b32 s69, s7, 7
    s_add_u32 s69, s69, 28
    s_cmp_lt_u32 s7, 56
    s_cselect_b32 s6, s68, s66
    s_cselect_b32 s67, s69, s67
    s_lshl_b32 s46, s6, 6
    s_add_u32 s46, s46, s67
    s_lshl_b32 s66, s67, 2
    s_lshr_b32 s67, s3, 1
    s_add_u32 s66, s66, s67
    s_mul_i32 s57, s6, 144
    s_add_u32 s57, s57, s66
    s_lshl_b32 s67, s66, 4
    s_sub_u32 s68, s66, 112
    s_lshr_b32 s69, s68, 1
    s_mul_i32 s69, s69, 28
    s_and_b32 s68, s68, 1
    s_lshl_b32 s68, s68, 4
    s_add_u32 s68, s68, s69
    s_mov_b32 s69, 401408
    s_cmp_lt_u32 s66, 112
    s_cselect_b32 s67, s67, s68
    s_cselect_b32 s40, s24, s16
    s_cselect_b32 s41, s25, s17
    s_cselect_b32 s42, 1605632, s69
    s_mov_b32 s43, 0x00020000
    s_and_b32 s68, s3, 1
    s_lshl_b32 s68, s68, 3
    s_add_u32 s67, s67, s68
    s_mul_i32 s67, s67, 896
    s_lshl_b32 s6, s6, 7
    s_add_u32 s61, s67, s6
    v_lshrrev_b32 v248, 3, v0
    v_mul_u32_u24 v248, 896, v248
    v_and_b32 v249, 7, v0
    v_lshl_add_u32 v2, v249, 4, v248
    s_add_u32 m0, s48, 49152
    v_lshl_add_u64 v[4:5], v[6:7], 0, v[4:5]
    global_load_lds_dwordx4 v[4:5], off
    s_add_u32 m0, s48, 32768
    s_mov_b32 s50, 128
    buffer_load_dwordx4 v3, s[32:35], s50 offen  lds
    s_add_u32 m0, s48, 57344
    v_lshl_add_u64 v[4:5], v[6:7], 0, v[4:5]
    global_load_lds_dwordx4 v[4:5], off
    s_add_u32 m0, s48, 40960
    s_mov_b32 s50, 57472
    buffer_load_dwordx4 v3, s[32:35], s50 offen  lds
    s_mov_b32 s36, s30
    s_mov_b32 s37, s31
    s_mov_b32 s38, 13922304
    s_mov_b32 s39, 0x00020000
    s_waitcnt lgkmcnt(0)
    s_add_u32 s58, s58, 1
    s_waitcnt vmcnt(9)
    v_lshlrev_b32 v108, 16, v104
    v_and_b32 v109, s49, v104
    v_lshlrev_b32 v110, 16, v105
    v_and_b32 v111, s49, v105
    v_lshlrev_b32 v112, 16, v106
    v_and_b32 v113, s49, v106
    v_lshlrev_b32 v114, 16, v107
    v_and_b32 v115, s49, v107
    v_add_f32 v104, v108, v109
    v_mul_f32 v105, v108, v108
    v_add_f32 v106, v110, v111
    v_mul_f32 v107, v109, v109
    v_fmac_f32 v105, v110, v110
    v_fmac_f32 v107, v111, v111
    v_fmac_f32 v105, v112, v112
    v_fmac_f32 v107, v113, v113
    v_fmac_f32 v105, v114, v114
    v_fmac_f32 v107, v115, v115
    v_add_f32 v108, v112, v113
    v_add_f32 v109, v114, v115
    v_add_f32 v104, v104, v106
    v_add_f32 v108, v108, v109
    v_add_f32 v105, v105, v107
    v_add_f32 v104, v104, v108
    s_nop 0
    v_add_f32_dpp v105, v105, v105 row_shr:1 row_mask:0xf bank_mask:0xf bound_ctrl:0
    v_add_f32_dpp v104, v104, v104 row_shr:1 row_mask:0xf bank_mask:0xf bound_ctrl:0
    s_nop 0
    v_add_f32_dpp v105, v105, v105 row_shr:2 row_mask:0xf bank_mask:0xf bound_ctrl:0
    v_add_f32_dpp v104, v104, v104 row_shr:2 row_mask:0xf bank_mask:0xf bound_ctrl:0
    s_nop 0
    v_add_f32_dpp v105, v105, v105 row_shr:4 row_mask:0xf bank_mask:0xf bound_ctrl:0
    v_add_f32_dpp v104, v104, v104 row_shr:4 row_mask:0xf bank_mask:0xf bound_ctrl:0
    s_nop 0
    v_add_f32_dpp v105, v105, v105 row_shr:8 row_mask:0xf bank_mask:0xf bound_ctrl:0
    v_add_f32_dpp v104, v104, v104 row_shr:8 row_mask:0xf bank_mask:0xf bound_ctrl:0
    s_nop 0
    v_add_f32_dpp v105, v105, v105 row_bcast:15 row_mask:0xa bank_mask:0xf
    v_add_f32_dpp v104, v104, v104 row_bcast:15 row_mask:0xa bank_mask:0xf
    s_nop 0
    v_add_f32_dpp v105, v105, v105 row_bcast:31 row_mask:0xc bank_mask:0xf
    v_add_f32_dpp v104, v104, v104 row_bcast:31 row_mask:0xc bank_mask:0xf
    s_nop 0
    v_mul_f32 v104, 991054117, v104
    v_mul_f32 v105, 991054117, v105
    v_fma_f32 v105, -v104, v104, v105
    v_max_f32 v105, 0, v105
    v_cvt_pk_bf16_f32 v105, v105, v105
    v_and_b32 v105, s49, v105
    v_add_f32 v105, 925353388, v105
    v_cvt_pk_bf16_f32 v105, v105, v105
    v_and_b32 v105, s49, v105
    v_sqrt_f32 v105, v105
    v_mov_b32 v108, s45
    v_cvt_pk_bf16_f32 v104, -v104, v105
    v_mov_b32 v105, s58
    s_mov_b32 exec_lo, 0
    s_mov_b32 exec_hi, 0x80000000
    buffer_store_dwordx2 v[104:105], v108, s[36:39], 0 offen sc1
    s_mov_b64 exec, -1
    s_waitcnt vmcnt(6)
    s_barrier
    ds_read_b128 v[128:131], v8 offset:0
    ds_read_b64_tr_b16 v[36:37], v12 offset:16384
    ds_read_b64_tr_b16 v[38:39], v12 offset:17408
    ds_read_b64_tr_b16 v[40:41], v16 offset:16384
    ds_read_b64_tr_b16 v[42:43], v16 offset:17408
    ds_read_b128 v[132:135], v9 offset:0
    ds_read_b64_tr_b16 v[44:45], v13 offset:16384
    ds_read_b64_tr_b16 v[46:47], v13 offset:17408
    ds_read_b64_tr_b16 v[48:49], v17 offset:16384
    ds_read_b64_tr_b16 v[50:51], v17 offset:17408
    s_add_u32 m0, s48, 81920
    v_lshl_add_u64 v[4:5], v[6:7], 0, v[4:5]
    global_load_lds_dwordx4 v[4:5], off
    s_add_u32 m0, s48, 65536
    s_mov_b32 s50, 256
    buffer_load_dwordx4 v3, s[32:35], s50 offen  lds
    s_lshl_b32 s6, s4, 2
    s_add_u32 s6, s6, s52
    s_mul_i32 s6, s6, 144
    s_lshl_b32 s10, s59, 2
    s_add_u32 s6, s6, s10
    s_waitcnt lgkmcnt(5)
    v_mfma_f32_32x32x16_bf16 v[64:79], v[36:39], v[128:131], 0
    ds_read_b64_tr_b16 v[52:53], v14 offset:16384
    ds_read_b64_tr_b16 v[54:55], v14 offset:17408
    v_mfma_f32_32x32x16_bf16 v[80:95], v[40:43], v[128:131], 0
    ds_read_b64_tr_b16 v[56:57], v18 offset:16384
    ds_read_b64_tr_b16 v[58:59], v18 offset:17408
    v_mfma_f32_16x16x32_bf16 v[28:31], v[24:27], v[36:39], 0
    ds_read_b128 v[136:139], v10 offset:0
    v_mfma_f32_16x16x32_bf16 v[32:35], v[24:27], v[40:43], 0
    s_add_u32 m0, s48, 90112
    v_lshl_add_u64 v[4:5], v[6:7], 0, v[4:5]
    global_load_lds_dwordx4 v[4:5], off
    s_add_u32 s6, s6, s55
    s_lshl_b32 s10, s6, 10
    s_add_u32 s11, s10, 1024
    s_lshl_b32 s6, s4, 2
    s_add_u32 s6, s6, s52
    s_waitcnt lgkmcnt(5)
    v_mfma_f32_32x32x16_bf16 v[64:79], v[44:47], v[132:135], v[64:79]
    ds_read_b64_tr_b16 v[36:37], v15 offset:16384
    ds_read_b64_tr_b16 v[38:39], v15 offset:17408
    v_mfma_f32_32x32x16_bf16 v[80:95], v[48:51], v[132:135], v[80:95]
    ds_read_b64_tr_b16 v[40:41], v19 offset:16384
    ds_read_b64_tr_b16 v[42:43], v19 offset:17408
    ds_read_b128 v[140:143], v11 offset:0
    s_add_u32 m0, s48, 73728
    s_mov_b32 s50, 57600
    buffer_load_dwordx4 v3, s[32:35], s50 offen  lds
    s_mul_i32 s6, s6, 144
    s_lshl_b32 s12, s60, 2
    s_add_u32 s6, s6, s12
    s_add_u32 s6, s6, s55
    s_lshl_b32 s12, s6, 10
    s_add_u32 s13, s12, 1024
    s_waitcnt lgkmcnt(5)
    v_mfma_f32_32x32x16_bf16 v[64:79], v[52:55], v[136:139], v[64:79]
    s_waitcnt vmcnt(5)
    s_barrier
    ds_read_b64_tr_b16 v[44:45], v12 offset:49152
    ds_read_b64_tr_b16 v[46:47], v12 offset:50176
    v_mfma_f32_32x32x16_bf16 v[80:95], v[56:59], v[136:139], v[80:95]
    ds_read_b64_tr_b16 v[48:49], v16 offset:49152
    ds_read_b64_tr_b16 v[50:51], v16 offset:50176
    ds_read_b128 v[144:147], v8 offset:32768
    s_add_u32 m0, s48, 114688
    v_lshl_add_u64 v[4:5], v[6:7], 0, v[4:5]
    global_load_lds_dwordx4 v[4:5], off
    s_lshl_b32 s18, s3, 12
    s_lshl_b32 s6, s53, 5
    s_add_u32 s6, s6, s52
    s_lshl_b32 s6, s6, 12
    s_add_u32 s15, s6, 13598720
    s_lshl_b32 s6, s4, 2
    s_waitcnt lgkmcnt(5)
    v_mfma_f32_32x32x16_bf16 v[64:79], v[36:39], v[140:143], v[64:79]
    ds_read_b64_tr_b16 v[52:53], v13 offset:49152
    ds_read_b64_tr_b16 v[54:55], v13 offset:50176
    v_mfma_f32_32x32x16_bf16 v[80:95], v[40:43], v[140:143], v[80:95]
    ds_read_b64_tr_b16 v[56:57], v17 offset:49152
    ds_read_b64_tr_b16 v[58:59], v17 offset:50176
    ds_read_b128 v[148:151], v9 offset:32768
    s_add_u32 m0, s48, 98304
    s_mov_b32 s50, 384
    buffer_load_dwordx4 v3, s[32:35], s50 offen  lds
    s_add_u32 s6, s6, s52
    s_lshl_b32 s7, s6, 4
    s_add_u32 s7, s7, s5
    s_lshl_b32 s7, s7, 11
    s_add_u32 s14, s7, 11501568
    s_mul_i32 s6, s6, 144
    s_waitcnt lgkmcnt(5)
    v_mfma_f32_32x32x16_bf16 v[64:79], v[44:47], v[144:147], v[64:79]
    ds_read_b64_tr_b16 v[36:37], v14 offset:49152
    ds_read_b64_tr_b16 v[38:39], v14 offset:50176
    v_mfma_f32_32x32x16_bf16 v[80:95], v[48:51], v[144:147], v[80:95]
    ds_read_b64_tr_b16 v[40:41], v18 offset:49152
    ds_read_b64_tr_b16 v[42:43], v18 offset:50176
    v_mfma_f32_16x16x32_bf16 v[28:31], v[24:27], v[44:47], v[28:31]
    ds_read_b128 v[152:155], v10 offset:32768
    v_mfma_f32_16x16x32_bf16 v[32:35], v[24:27], v[48:51], v[32:35]
    s_add_u32 m0, s48, 122880
    v_lshl_add_u64 v[4:5], v[6:7], 0, v[4:5]
    global_load_lds_dwordx4 v[4:5], off
    s_lshl_b32 s7, s5, 1
    s_add_u32 s6, s6, s7
    s_add_u32 s6, s6, s53
    s_add_u32 s6, s6, 112
    s_lshl_b32 s22, s6, 10
    s_lshr_b32 s6, s5, 3
    s_waitcnt lgkmcnt(5)
    v_mfma_f32_32x32x16_bf16 v[64:79], v[52:55], v[148:151], v[64:79]
    ds_read_b64_tr_b16 v[44:45], v15 offset:49152
    ds_read_b64_tr_b16 v[46:47], v15 offset:50176
    v_mfma_f32_32x32x16_bf16 v[80:95], v[56:59], v[148:151], v[80:95]
    ds_read_b64_tr_b16 v[48:49], v19 offset:49152
    ds_read_b64_tr_b16 v[50:51], v19 offset:50176
    ds_read_b128 v[156:159], v11 offset:32768
    s_add_u32 m0, s48, 106496
    s_mov_b32 s50, 57728
    buffer_load_dwordx4 v3, s[32:35], s50 offen  lds
    s_lshl_b32 s7, s4, 1
    s_add_u32 s6, s6, s7
    s_and_b32 s7, s5, 7
    s_mul_i32 s66, s3, 6
    s_lshl_b32 s28, s3, 1
    s_add_u32 s28, s28, 44
    s_waitcnt lgkmcnt(5)
    v_mfma_f32_32x32x16_bf16 v[64:79], v[36:39], v[152:155], v[64:79]
    s_waitcnt vmcnt(4)
    s_barrier
    v_xor_b32 v12, 0x10000, v12
    v_xor_b32 v16, 0x10000, v16
    v_xor_b32 v8, 0x10000, v8
    ds_read_b64_tr_b16 v[52:53], v12 offset:16384
    ds_read_b64_tr_b16 v[54:55], v12 offset:17408
    v_mfma_f32_32x32x16_bf16 v[80:95], v[40:43], v[152:155], v[80:95]
    ds_read_b64_tr_b16 v[56:57], v16 offset:16384
    ds_read_b64_tr_b16 v[58:59], v16 offset:17408
    ds_read_b128 v[160:163], v8 offset:0
    s_add_u32 m0, s48, 16384
    v_lshl_add_u64 v[4:5], v[6:7], 0, v[4:5]
    global_load_lds_dwordx4 v[4:5], off
    s_lshl_b32 s28, s28, 10
    s_lshl_b32 s23, s28, 1
    s_mul_i32 s20, s6, 288
    s_add_u32 s20, s20, s66
    s_lshl_b32 s20, s20, 10
    s_add_u32 s21, s20, 147456
    s_waitcnt lgkmcnt(5)
    v_mfma_f32_32x32x16_bf16 v[64:79], v[44:47], v[156:159], v[64:79]
    v_xor_b32 v13, 0x10000, v13
    v_xor_b32 v17, 0x10000, v17
    v_xor_b32 v9, 0x10000, v9
    ds_read_b64_tr_b16 v[36:37], v13 offset:16384
    ds_read_b64_tr_b16 v[38:39], v13 offset:17408
    v_mfma_f32_32x32x16_bf16 v[80:95], v[48:51], v[156:159], v[80:95]
    ds_read_b64_tr_b16 v[40:41], v17 offset:16384
    ds_read_b64_tr_b16 v[42:43], v17 offset:17408
    ds_read_b128 v[164:167], v9 offset:0
    s_add_u32 m0, s48, 0
    s_mov_b32 s50, 512
    buffer_load_dwordx4 v3, s[32:35], s50 offen  lds
    s_bitcmp1_b32 s3, 0
    s_cselect_b32 s67, s21, s20
    s_cselect_b32 s21, s20, s21
    s_mov_b32 s20, s67
    s_mul_i32 s19, s7, 144
    s_add_u32 s19, s19, s66
    s_lshl_b32 s19, s19, 11
    s_add_u32 s19, s19, 9437184
    s_waitcnt lgkmcnt(5)
    v_mfma_f32_32x32x16_bf16 v[64:79], v[52:55], v[160:163], v[64:79]
    v_xor_b32 v14, 0x10000, v14
    v_xor_b32 v18, 0x10000, v18
    v_xor_b32 v10, 0x10000, v10
    ds_read_b64_tr_b16 v[44:45], v14 offset:16384
    ds_read_b64_tr_b16 v[46:47], v14 offset:17408
    v_mfma_f32_32x32x16_bf16 v[80:95], v[56:59], v[160:163], v[80:95]
    ds_read_b64_tr_b16 v[48:49], v18 offset:16384
    ds_read_b64_tr_b16 v[50:51], v18 offset:17408
    v_mfma_f32_16x16x32_bf16 v[28:31], v[24:27], v[52:55], v[28:31]
    ds_read_b128 v[168:171], v10 offset:0
    v_mfma_f32_16x16x32_bf16 v[32:35], v[24:27], v[56:59], v[32:35]
    s_add_u32 m0, s48, 24576
    v_lshl_add_u64 v[4:5], v[6:7], 0, v[4:5]
    global_load_lds_dwordx4 v[4:5], off
    s_lshr_b32 s66, s3, 1
    s_lshl_b32 s66, s66, 3
    s_mul_i32 s29, s7, 144
    s_add_u32 s29, s29, s66
    s_add_u32 s29, s29, 112
    s_lshl_b32 s29, s29, 11
    s_waitcnt lgkmcnt(5)
    v_mfma_f32_32x32x16_bf16 v[64:79], v[36:39], v[164:167], v[64:79]
    v_xor_b32 v15, 0x10000, v15
    v_xor_b32 v19, 0x10000, v19
    v_xor_b32 v11, 0x10000, v11
    ds_read_b64_tr_b16 v[52:53], v15 offset:16384
    ds_read_b64_tr_b16 v[54:55], v15 offset:17408
    v_mfma_f32_32x32x16_bf16 v[80:95], v[40:43], v[164:167], v[80:95]
    ds_read_b64_tr_b16 v[56:57], v19 offset:16384
    ds_read_b64_tr_b16 v[58:59], v19 offset:17408
    ds_read_b128 v[172:175], v11 offset:0
    s_add_u32 m0, s48, 8192
    s_mov_b32 s50, 57856
    buffer_load_dwordx4 v3, s[32:35], s50 offen  lds
    s_add_u32 s29, s29, 9437184
    s_and_b32 s67, s3, 1
    s_lshl_b32 s67, s67, 12
    s_add_u32 s29, s29, s67
    s_lshl_b32 s44, s3, 12
    v_and_b32 v248, 31, v0
    s_waitcnt lgkmcnt(5)
    v_mfma_f32_32x32x16_bf16 v[64:79], v[44:47], v[168:171], v[64:79]
    s_waitcnt vmcnt(4)
    s_barrier
    ds_read_b64_tr_b16 v[36:37], v12 offset:49152
    ds_read_b64_tr_b16 v[38:39], v12 offset:50176
    v_mfma_f32_32x32x16_bf16 v[80:95], v[48:51], v[168:171], v[80:95]
    ds_read_b64_tr_b16 v[40:41], v16 offset:49152
    ds_read_b64_tr_b16 v[42:43], v16 offset:50176
    ds_read_b128 v[176:179], v8 offset:32768
    s_add_u32 m0, s48, 49152
    v_lshl_add_u64 v[4:5], v[6:7], 0, v[4:5]
    global_load_lds_dwordx4 v[4:5], off
    s_lshl_b32 s6, s55, 9
    s_add_u32 s6, s6, 139264
    v_lshl_add_u32 v248, v248, 4, s6
    s_lshl_b32 s6, s52, 2
    v_add_u32 v249, s6, v248
    s_lshr_b32 s6, s3, 1
    s_waitcnt lgkmcnt(5)
    v_mfma_f32_32x32x16_bf16 v[64:79], v[52:55], v[172:175], v[64:79]
    ds_read_b64_tr_b16 v[44:45], v13 offset:49152
    ds_read_b64_tr_b16 v[46:47], v13 offset:50176
    v_mfma_f32_32x32x16_bf16 v[80:95], v[56:59], v[172:175], v[80:95]
    ds_read_b64_tr_b16 v[48:49], v17 offset:49152
    ds_read_b64_tr_b16 v[50:51], v17 offset:50176
    ds_read_b128 v[180:183], v9 offset:32768
    s_add_u32 m0, s48, 32768
    s_mov_b32 s50, 640
    buffer_load_dwordx4 v3, s[32:35], s50 offen  lds
    s_lshl_b32 s6, s6, 11
    s_and_b32 s7, s3, 1
    s_lshl_b32 s47, s7, 6
    s_add_u32 s47, s47, s6
    s_add_u32 s47, s47, 131072
    s_lshl_b32 s6, s57, 11
    s_waitcnt lgkmcnt(5)
    v_mfma_f32_32x32x16_bf16 v[64:79], v[36:39], v[176:179], v[64:79]
    ds_read_b64_tr_b16 v[52:53], v14 offset:49152
    ds_read_b64_tr_b16 v[54:55], v14 offset:50176
    v_mfma_f32_32x32x16_bf16 v[80:95], v[40:43], v[176:179], v[80:95]
    ds_read_b64_tr_b16 v[56:57], v18 offset:49152
    ds_read_b64_tr_b16 v[58:59], v18 offset:50176
    v_mfma_f32_16x16x32_bf16 v[28:31], v[24:27], v[36:39], v[28:31]
    ds_read_b128 v[184:187], v10 offset:32768
    v_mfma_f32_16x16x32_bf16 v[32:35], v[24:27], v[40:43], v[32:35]
    s_add_u32 m0, s48, 57344
    v_lshl_add_u64 v[4:5], v[6:7], 0, v[4:5]
    global_load_lds_dwordx4 v[4:5], off
    s_lshl_b32 s7, s7, 10
    s_add_u32 s6, s6, s7
    s_add_u32 s59, s6, 9437184
    s_mov_b32 s17, 0x00003f80
    s_cmp_lt_u32 s62, 2
    s_cselect_b32 s16, 0x3f803f80, s17
    s_cselect_b32 s17, s17, 0
    s_lshl_b32 s6, s4, 2
    s_waitcnt lgkmcnt(5)
    v_mfma_f32_32x32x16_bf16 v[64:79], v[44:47], v[180:183], v[64:79]
    ds_read_b64_tr_b16 v[36:37], v15 offset:49152
    ds_read_b64_tr_b16 v[38:39], v15 offset:50176
    v_mfma_f32_32x32x16_bf16 v[80:95], v[48:51], v[180:183], v[80:95]
    ds_read_b64_tr_b16 v[40:41], v19 offset:49152
    ds_read_b64_tr_b16 v[42:43], v19 offset:50176
    ds_read_b128 v[188:191], v11 offset:32768
    s_add_u32 m0, s48, 40960
    s_mov_b32 s50, 57984
    buffer_load_dwordx4 v3, s[32:35], s50 offen  lds
    s_add_u32 s6, s6, s52
    s_lshl_b32 s25, s6, 12
    s_lshl_b32 s6, s6, 2
    s_add_u32 s6, s6, s62
    s_lshl_b32 s6, s6, 2
    s_add_u32 s6, s6, s55
    s_waitcnt lgkmcnt(5)
    v_mfma_f32_32x32x16_bf16 v[64:79], v[52:55], v[184:187], v[64:79]
    s_waitcnt vmcnt(4)
    s_barrier
    v_xor_b32 v12, 0x10000, v12
    v_xor_b32 v16, 0x10000, v16
    v_xor_b32 v8, 0x10000, v8
    ds_read_b64_tr_b16 v[44:45], v12 offset:16384
    ds_read_b64_tr_b16 v[46:47], v12 offset:17408
    v_mfma_f32_32x32x16_bf16 v[80:95], v[56:59], v[184:187], v[80:95]
    ds_read_b64_tr_b16 v[48:49], v16 offset:16384
    ds_read_b64_tr_b16 v[50:51], v16 offset:17408
    ds_read_b128 v[192:195], v8 offset:0
    s_add_u32 m0, s48, 81920
    v_lshl_add_u64 v[4:5], v[6:7], 0, v[4:5]
    global_load_lds_dwordx4 v[4:5], off
    s_lshl_b32 s6, s6, 11
    s_add_u32 s54, s6, 11501568
    s_and_b32 s6, s62, 1
    s_lshl_b32 s7, s6, 8
    s_add_u32 s7, s7, 2048
    s_lshl_b32 s6, s6, 10
    s_waitcnt lgkmcnt(5)
    v_mfma_f32_32x32x16_bf16 v[64:79], v[36:39], v[188:191], v[64:79]
    v_xor_b32 v13, 0x10000, v13
    v_xor_b32 v17, 0x10000, v17
    v_xor_b32 v9, 0x10000, v9
    ds_read_b64_tr_b16 v[52:53], v13 offset:16384
    ds_read_b64_tr_b16 v[54:55], v13 offset:17408
    v_mfma_f32_32x32x16_bf16 v[80:95], v[40:43], v[188:191], v[80:95]
    ds_read_b64_tr_b16 v[56:57], v17 offset:16384
    ds_read_b64_tr_b16 v[58:59], v17 offset:17408
    ds_read_b128 v[196:199], v9 offset:0
    s_add_u32 m0, s48, 65536
    s_mov_b32 s50, 768
    buffer_load_dwordx4 v3, s[32:35], s50 offen  lds
    s_cmp_lt_u32 s62, 2
    s_cselect_b32 s6, s6, s7
    s_add_u32 s25, s25, s6
    s_add_u32 s25, s25, 13598720
    v_and_b32 v255, 31, v0
    v_lshlrev_b32 v255, 5, v255
    s_lshl_b32 s66, s52, 10
    s_waitcnt lgkmcnt(5)
    v_mfma_f32_32x32x16_bf16 v[64:79], v[44:47], v[192:195], v[64:79]
    v_xor_b32 v14, 0x10000, v14
    v_xor_b32 v18, 0x10000, v18
    v_xor_b32 v10, 0x10000, v10
    ds_read_b64_tr_b16 v[36:37], v14 offset:16384
    ds_read_b64_tr_b16 v[38:39], v14 offset:17408
    v_mfma_f32_32x32x16_bf16 v[80:95], v[48:51], v[192:195], v[80:95]
    ds_read_b64_tr_b16 v[40:41], v18 offset:16384
    ds_read_b64_tr_b16 v[42:43], v18 offset:17408
    v_mfma_f32_16x16x32_bf16 v[28:31], v[24:27], v[44:47], v[28:31]
    ds_read_b128 v[200:203], v10 offset:0
    v_mfma_f32_16x16x32_bf16 v[32:35], v[24:27], v[48:51], v[32:35]
    s_add_u32 m0, s48, 90112
    v_lshl_add_u64 v[4:5], v[6:7], 0, v[4:5]
    global_load_lds_dwordx4 v[4:5], off
    s_add_u32 s66, s66, 147456
    v_add_u32 v255, s66, v255
    s_sub_u32 s6, 3, s55
    s_lshl_b32 s7, s55, 2
    s_lshr_b32 s7, 0x0132, s7
    s_and_b32 s7, s7, 3
    s_waitcnt lgkmcnt(5)
    v_mfma_f32_32x32x16_bf16 v[64:79], v[52:55], v[196:199], v[64:79]
    v_xor_b32 v15, 0x10000, v15
    v_xor_b32 v19, 0x10000, v19
    v_xor_b32 v11, 0x10000, v11
    ds_read_b64_tr_b16 v[44:45], v15 offset:16384
    ds_read_b64_tr_b16 v[46:47], v15 offset:17408
    v_mfma_f32_32x32x16_bf16 v[80:95], v[56:59], v[196:199], v[80:95]
    ds_read_b64_tr_b16 v[48:49], v19 offset:16384
    ds_read_b64_tr_b16 v[50:51], v19 offset:17408
    ds_read_b128 v[204:207], v11 offset:0
    s_add_u32 m0, s48, 73728
    s_mov_b32 s50, 58112
    buffer_load_dwordx4 v3, s[32:35], s50 offen  lds
    s_bitcmp1_b32 s62, 0
    s_cselect_b32 s6, s7, s6
    s_cselect_b32 s24, s7, 0
    s_lshl_b32 s6, s6, 3
    v_add_u32 v253, s6, v255
    s_sub_u32 s6, 3, s56
    s_lshl_b32 s7, s56, 2
    s_lshr_b32 s7, 0x0132, s7
    s_waitcnt lgkmcnt(5)
    v_mfma_f32_32x32x16_bf16 v[64:79], v[36:39], v[200:203], v[64:79]
    s_waitcnt vmcnt(4)
    s_barrier
    ds_read_b64_tr_b16 v[52:53], v12 offset:49152
    s_lshl_b32 s72, s4, 2
    s_add_u32 s72, s72, s52
    ds_read_b64_tr_b16 v[54:55], v12 offset:50176
    s_lshl_b32 s72, s72, 8
    s_add_u32 s72, s72, 13905920
    v_mfma_f32_32x32x16_bf16 v[80:95], v[40:43], v[200:203], v[80:95]
    ds_read_b64_tr_b16 v[56:57], v16 offset:49152
    v_and_b32 v240, 31, v0
    v_lshl_add_u32 v240, v240, 3, s72
    ds_read_b64_tr_b16 v[58:59], v16 offset:50176
    buffer_load_dwordx2 v[62:63], v240, s[36:39], 0 offen sc1
    ds_read_b128 v[208:211], v8 offset:32768
    v_mov_b32 v4, v102
    v_mov_b32 v5, v103
    v_mov_b32 v6, 114688
    s_add_u32 m0, s48, 98304
    s_nop 0
    global_load_lds_dwordx4 v[4:5], off
    s_and_b32 s7, s7, 3
    s_bitcmp1_b32 s62, 0
    s_cselect_b32 s6, s7, s6
    s_cselect_b32 s24, s7, 0
    s_lshl_b32 s6, s6, 3
    v_add_u32 v254, s6, v255
    v_lshrrev_b32 v252, 5, v0
    v_lshl_add_u32 v255, v252, 3, v255
    s_waitcnt lgkmcnt(5)
    v_mfma_f32_32x32x16_bf16 v[64:79], v[44:47], v[204:207], v[64:79]
    ds_read_b64_tr_b16 v[36:37], v13 offset:49152
    ds_read_b64_tr_b16 v[38:39], v13 offset:50176
    v_mfma_f32_32x32x16_bf16 v[80:95], v[48:51], v[204:207], v[80:95]
    ds_read_b64_tr_b16 v[40:41], v17 offset:49152
    ds_read_b64_tr_b16 v[42:43], v17 offset:50176
    ds_read_b128 v[212:215], v9 offset:32768
    s_add_u32 m0, s48, 106496
    v_lshl_add_u64 v[4:5], v[6:7], 0, v[4:5]
    global_load_lds_dwordx4 v[4:5], off
    v_lshlrev_b32 v241, 2, v252
    v_bfe_u32 v252, v0, 4, 1
    v_add_u32 v241, v241, v252
    v_bfe_u32 v252, v0, 2, 2
    v_lshl_add_u32 v241, v241, 2, v252
    v_lshlrev_b32 v241, 5, v241
    s_waitcnt lgkmcnt(5)
    v_mfma_f32_32x32x16_bf16 v[64:79], v[52:55], v[208:211], v[64:79]
    ds_read_b64_tr_b16 v[44:45], v14 offset:49152
    ds_read_b64_tr_b16 v[46:47], v14 offset:50176
    v_mfma_f32_32x32x16_bf16 v[80:95], v[56:59], v[208:211], v[80:95]
    ds_read_b64_tr_b16 v[48:49], v18 offset:49152
    ds_read_b64_tr_b16 v[50:51], v18 offset:50176
    v_mfma_f32_16x16x32_bf16 v[28:31], v[24:27], v[52:55], v[28:31]
    ds_read_b128 v[216:219], v10 offset:32768
    v_mfma_f32_16x16x32_bf16 v[32:35], v[24:27], v[56:59], v[32:35]
    s_add_u32 m0, s48, 114688
    v_lshl_add_u64 v[4:5], v[6:7], 0, v[4:5]
    global_load_lds_dwordx4 v[4:5], off
    v_and_b32 v252, 3, v0
    v_lshl_add_u32 v241, v252, 3, v241
    v_add_u32 v241, s66, v241
    s_cmp_lt_u32 s62, 2
    s_cselect_b64 vcc, -1, 0
    v_cndmask_b32 v255, v241, v255, vcc
    s_waitcnt lgkmcnt(5)
    v_mfma_f32_32x32x16_bf16 v[64:79], v[36:39], v[212:215], v[64:79]
    ds_read_b64_tr_b16 v[52:53], v15 offset:49152
    ds_read_b64_tr_b16 v[54:55], v15 offset:50176
    v_mfma_f32_32x32x16_bf16 v[80:95], v[40:43], v[212:215], v[80:95]
    ds_read_b64_tr_b16 v[56:57], v19 offset:49152
    ds_read_b64_tr_b16 v[58:59], v19 offset:50176
    ds_read_b128 v[220:223], v11 offset:32768
    s_add_u32 m0, s48, 122880
    v_lshl_add_u64 v[4:5], v[6:7], 0, v[4:5]
    global_load_lds_dwordx4 v[4:5], off
    s_waitcnt lgkmcnt(5)
    v_mfma_f32_32x32x16_bf16 v[64:79], v[44:47], v[216:219], v[64:79]
    s_waitcnt vmcnt(5)
    s_barrier
    v_xor_b32 v12, 0x10000, v12
    v_xor_b32 v16, 0x10000, v16
    v_xor_b32 v8, 0x10000, v8
    ds_read_b64_tr_b16 v[36:37], v12 offset:16384
    ds_read_b64_tr_b16 v[38:39], v12 offset:17408
    v_mfma_f32_32x32x16_bf16 v[80:95], v[48:51], v[216:219], v[80:95]
    ds_read_b64_tr_b16 v[40:41], v16 offset:16384
    ds_read_b64_tr_b16 v[42:43], v16 offset:17408
    ds_read_b128 v[224:227], v8 offset:0
    s_add_u32 m0, s48, 0
    v_lshl_add_u64 v[4:5], v[6:7], 0, v[4:5]
    global_load_lds_dwordx4 v[4:5], off
    s_waitcnt lgkmcnt(5)
    v_mfma_f32_32x32x16_bf16 v[64:79], v[52:55], v[220:223], v[64:79]
    v_xor_b32 v13, 0x10000, v13
    v_xor_b32 v17, 0x10000, v17
    v_xor_b32 v9, 0x10000, v9
    ds_read_b64_tr_b16 v[44:45], v13 offset:16384
    ds_read_b64_tr_b16 v[46:47], v13 offset:17408
    v_mfma_f32_32x32x16_bf16 v[80:95], v[56:59], v[220:223], v[80:95]
    ds_read_b64_tr_b16 v[48:49], v17 offset:16384
    ds_read_b64_tr_b16 v[50:51], v17 offset:17408
    ds_read_b128 v[228:231], v9 offset:0
    s_add_u32 m0, s48, 8192
    v_lshl_add_u64 v[4:5], v[6:7], 0, v[4:5]
    global_load_lds_dwordx4 v[4:5], off
    s_waitcnt lgkmcnt(5)
    v_mfma_f32_32x32x16_bf16 v[64:79], v[36:39], v[224:227], v[64:79]
    v_xor_b32 v14, 0x10000, v14
    v_xor_b32 v18, 0x10000, v18
    v_xor_b32 v10, 0x10000, v10
    ds_read_b64_tr_b16 v[52:53], v14 offset:16384
    ds_read_b64_tr_b16 v[54:55], v14 offset:17408
    v_mfma_f32_32x32x16_bf16 v[80:95], v[40:43], v[224:227], v[80:95]
    ds_read_b64_tr_b16 v[56:57], v18 offset:16384
    ds_read_b64_tr_b16 v[58:59], v18 offset:17408
    v_mfma_f32_16x16x32_bf16 v[28:31], v[24:27], v[36:39], v[28:31]
    ds_read_b128 v[232:235], v10 offset:0
    v_mfma_f32_16x16x32_bf16 v[32:35], v[24:27], v[40:43], v[32:35]
    s_add_u32 m0, s48, 16384
    v_lshl_add_u64 v[4:5], v[6:7], 0, v[4:5]
    global_load_lds_dwordx4 v[4:5], off
    s_waitcnt lgkmcnt(5)
    v_mfma_f32_32x32x16_bf16 v[64:79], v[44:47], v[228:231], v[64:79]
    v_xor_b32 v15, 0x10000, v15
    v_xor_b32 v19, 0x10000, v19
    v_xor_b32 v11, 0x10000, v11
    ds_read_b64_tr_b16 v[36:37], v15 offset:16384
    s_nop 1
    ds_read_b64_tr_b16 v[38:39], v15 offset:17408
    v_mfma_f32_32x32x16_bf16 v[80:95], v[48:51], v[228:231], v[80:95]
    ds_read_b64_tr_b16 v[40:41], v19 offset:16384
    s_mov_b64 exec, 0xffff
    ds_write_b32 v249, v28 offset:0
    ds_write_b32 v249, v29 offset:256
    ds_write_b32 v249, v32 offset:512
    ds_write_b32 v249, v33 offset:768
    s_mov_b64 exec, -1
    ds_read_b64_tr_b16 v[42:43], v19 offset:17408
    ds_read_b128 v[236:239], v11 offset:0
    s_add_u32 m0, s48, 24576
    v_lshl_add_u64 v[4:5], v[6:7], 0, v[4:5]
    global_load_lds_dwordx4 v[4:5], off
    s_waitcnt lgkmcnt(9)
    v_mfma_f32_32x32x16_bf16 v[64:79], v[52:55], v[232:235], v[64:79]
    s_waitcnt vmcnt(8)
    v_cmp_ne_u32 vcc, s58, v63
    s_cbranch_vccz sok_1
    s_mov_b32 s74, 2097152
ssp_2:
    s_sleep 4
    buffer_load_dwordx2 v[62:63], v240, s[36:39], 0 offen sc1
    s_sub_u32 s74, s74, 1
    s_waitcnt vmcnt(0)
    v_cmp_ne_u32 vcc, s58, v63
    s_cmp_eq_u32 s74, 0
    s_cbranch_scc1 sok_1
    s_cbranch_vccnz ssp_2
sok_1:
    s_waitcnt lgkmcnt(2)
    s_waitcnt vmcnt(4)
    s_barrier
    v_xor_b32 v12, 65536, v250
    v_xor_b32 v16, 65536, v251
    ds_read_b64_tr_b16 v[44:45], v12 offset:32768
    ds_read_b128 v[240:243], v248 offset:0
    ds_read_b128 v[244:247], v248 offset:512
    ds_read_b64_tr_b16 v[46:47], v12 offset:33792
    v_and_b32 v9, s49, v62
    v_and_b32 v60, 0xffff, v62
    v_rcp_f32 v8, v9
    v_mfma_f32_32x32x16_bf16 v[80:95], v[56:59], v[232:235], v[80:95]
    ds_read_b64_tr_b16 v[48:49], v16 offset:32768
    v_lshl_or_b32 v60, v62, 16, v60
    v_mul_f32 v3, v9, v9
    ds_read_b64_tr_b16 v[50:51], v16 offset:33792
    v_mul_f32 v10, 3222493025, v8
    v_mul_f32 v11, v8, v8
    v_mov_b32 v21, 0
    s_add_u32 m0, s48, 32768
    v_lshl_add_u64 v[4:5], v[6:7], 0, v[4:5]
    global_load_lds_dwordx4 v[4:5], off
    s_waitcnt lgkmcnt(6)
    v_mfma_f32_32x32x16_bf16 v[64:79], v[36:39], v[236:239], v[64:79]
    v_xor_b32 v13, 69632, v250
    v_xor_b32 v17, 69632, v251
    ds_read_b64_tr_b16 v[52:53], v13 offset:32768
    v_mul_f32 v11, v11, v10
    v_mov_b32 v23, 0
    ds_read_b64_tr_b16 v[54:55], v13 offset:33792
    v_mul_f32 v11, 1027024659, v11
    v_mov_b32 v61, 0
    v_mov_b32 v62, 0
    v_mfma_f32_32x32x16_bf16 v[80:95], v[40:43], v[236:239], v[80:95]
    ds_read_b64_tr_b16 v[56:57], v17 offset:32768
    v_mov_b32 v63, 0
    s_waitcnt lgkmcnt(6)
    ds_read_b64_tr_b16 v[58:59], v17 offset:33792
    v_add_f32 v240, v240, v241
    v_add_f32 v242, v242, v243
    v_add_f32 v244, v244, v245
    s_add_u32 m0, s48, 40960
    v_lshl_add_u64 v[4:5], v[6:7], 0, v[4:5]
    global_load_lds_dwordx4 v[4:5], off
    s_cmp_eq_u32 s63, 1
    s_cbranch_scc1 B_p2q
    s_waitcnt lgkmcnt(4)
    v_mfma_f32_32x32x16_bf16 v[96:111], v[44:47], v[128:131], 0
    v_xor_b32 v14, 73728, v250
    v_xor_b32 v18, 73728, v251
    ds_read_b64_tr_b16 v[36:37], v14 offset:32768
    v_add_f32 v246, v246, v247
    v_add_f32 v240, v240, v242
    ds_read_b64_tr_b16 v[38:39], v14 offset:33792
    v_add_f32 v244, v244, v246
    v_cvt_pk_bf16_f32 v241, v240, v240
    v_mfma_f32_32x32x16_bf16 v[112:127], v[48:51], v[128:131], 0
    ds_read_b64_tr_b16 v[40:41], v18 offset:32768
    v_cvt_pk_bf16_f32 v245, v244, v244
    v_and_b32 v241, s49, v241
    ds_read_b64_tr_b16 v[42:43], v18 offset:33792
    v_and_b32 v245, s49, v245
    v_sub_f32 v241, v240, v241
    v_mfma_f32_16x16x32_bf16 v[28:31], v[24:27], v[44:47], 0
    v_mfma_f32_16x16x32_bf16 v[32:35], v[24:27], v[48:51], 0
    s_add_u32 m0, s48, 49152
    v_lshl_add_u64 v[4:5], v[6:7], 0, v[4:5]
    global_load_lds_dwordx4 v[4:5], off
    s_waitcnt lgkmcnt(4)
    v_mfma_f32_32x32x16_bf16 v[96:111], v[52:55], v[132:135], v[96:111]
    v_xor_b32 v15, 77824, v250
    v_xor_b32 v19, 77824, v251
    ds_read_b64_tr_b16 v[44:45], v15 offset:32768
    v_sub_f32 v245, v244, v245
    v_cvt_pk_bf16_f32 v240, v240, v241
    ds_read_b64_tr_b16 v[46:47], v15 offset:33792
    v_cvt_pk_bf16_f32 v244, v244, v245
    v_cndmask_b32 v20, v240, 0, s[64:65]
    v_mfma_f32_32x32x16_bf16 v[112:127], v[56:59], v[132:135], v[112:127]
    ds_read_b64_tr_b16 v[48:49], v19 offset:32768
    v_cndmask_b32 v22, v244, 0, s[64:65]
    s_nop 1
    ds_read_b64_tr_b16 v[50:51], v19 offset:33792
    v_mfma_f32_32x32x16_bf16 v[64:79], v[20:23], v[60:63], v[64:79]
    v_mfma_f32_32x32x16_bf16 v[80:95], v[22:25], v[60:63], v[80:95]
    s_add_u32 m0, s48, 57344
    v_lshl_add_u64 v[4:5], v[6:7], 0, v[4:5]
    global_load_lds_dwordx4 v[4:5], off
    s_waitcnt lgkmcnt(4)
    v_mfma_f32_32x32x16_bf16 v[96:111], v[36:39], v[136:139], v[96:111]
    ds_read_b64_tr_b16 v[52:53], v12 offset:49152
    s_nop 7
    v_mul_f32 v240, v64, v64
    ds_read_b64_tr_b16 v[54:55], v12 offset:50176
    v_mul_f32 v241, v65, v65
    v_mul_f32 v242, v66, v66
    v_mfma_f32_32x32x16_bf16 v[112:127], v[40:43], v[136:139], v[112:127]
    ds_read_b64_tr_b16 v[56:57], v16 offset:49152
    v_mul_f32 v243, v67, v67
    v_mul_f32 v244, v68, v68
    ds_read_b64_tr_b16 v[58:59], v16 offset:50176
    v_mul_f32 v245, v69, v69
    v_mul_f32 v246, v70, v70
    s_waitcnt lgkmcnt(4)
    v_mfma_f32_32x32x16_bf16 v[96:111], v[44:47], v[140:143], v[96:111]
    ds_read_b64_tr_b16 v[36:37], v13 offset:49152
    v_mul_f32 v247, v71, v71
    v_fma_f32 v240, v240, v11, v10
    ds_read_b64_tr_b16 v[38:39], v13 offset:50176
    v_fma_f32 v241, v241, v11, v10
    v_fma_f32 v242, v242, v11, v10
    v_mfma_f32_32x32x16_bf16 v[112:127], v[48:51], v[140:143], v[112:127]
    ds_read_b64_tr_b16 v[40:41], v17 offset:49152
    v_fma_f32 v243, v243, v11, v10
    v_fma_f32 v244, v244, v11, v10
    ds_read_b64_tr_b16 v[42:43], v17 offset:50176
    v_fma_f32 v245, v245, v11, v10
    v_fma_f32 v246, v246, v11, v10
    s_waitcnt lgkmcnt(4)
    v_mfma_f32_32x32x16_bf16 v[96:111], v[52:55], v[144:147], v[96:111]
    ds_read_b64_tr_b16 v[44:45], v14 offset:49152
    v_fma_f32 v247, v247, v11, v10
    v_mul_f32 v240, v240, v64
    ds_read_b64_tr_b16 v[46:47], v14 offset:50176
    v_mul_f32 v241, v241, v65
    v_mul_f32 v242, v242, v66
    v_mfma_f32_32x32x16_bf16 v[112:127], v[56:59], v[144:147], v[112:127]
    ds_read_b64_tr_b16 v[48:49], v18 offset:49152
    v_mul_f32 v243, v243, v67
    v_mul_f32 v244, v244, v68
    ds_read_b64_tr_b16 v[50:51], v18 offset:50176
    v_mul_f32 v245, v245, v69
    v_mul_f32 v246, v246, v70
    v_mfma_f32_16x16x32_bf16 v[28:31], v[24:27], v[52:55], v[28:31]
    v_mfma_f32_16x16x32_bf16 v[32:35], v[24:27], v[56:59], v[32:35]
    s_waitcnt lgkmcnt(4)
    v_mfma_f32_32x32x16_bf16 v[96:111], v[36:39], v[148:151], v[96:111]
    ds_read_b64_tr_b16 v[52:53], v15 offset:49152
    v_mul_f32 v247, v247, v71
    v_exp_f32 v240, v240
    ds_read_b64_tr_b16 v[54:55], v15 offset:50176
    v_mul_f32 v64, v64, v72
    v_exp_f32 v241, v241
    v_mfma_f32_32x32x16_bf16 v[112:127], v[40:43], v[148:151], v[112:127]
    ds_read_b64_tr_b16 v[56:57], v19 offset:49152
    v_mul_f32 v65, v65, v73
    v_exp_f32 v242, v242
    ds_read_b64_tr_b16 v[58:59], v19 offset:50176
    v_mul_f32 v66, v66, v74
    v_exp_f32 v243, v243
    s_waitcnt lgkmcnt(4)
    v_mfma_f32_32x32x16_bf16 v[96:111], v[44:47], v[152:155], v[96:111]
    s_waitcnt vmcnt(4)
    s_barrier
    v_xor_b32 v12, 0x10000, v12
    v_xor_b32 v16, 0x10000, v16
    ds_read_b64_tr_b16 v[36:37], v12 offset:0
    v_mul_f32 v67, v67, v75
    v_exp_f32 v244, v244
    ds_read_b64_tr_b16 v[38:39], v12 offset:1024
    v_mul_f32 v68, v68, v76
    v_exp_f32 v245, v245
    v_mfma_f32_32x32x16_bf16 v[112:127], v[48:51], v[152:155], v[112:127]
    ds_read_b64_tr_b16 v[40:41], v16 offset:0
    v_mul_f32 v69, v69, v77
    v_exp_f32 v246, v246
    ds_read_b64_tr_b16 v[42:43], v16 offset:1024
    v_mul_f32 v70, v70, v78
    v_exp_f32 v247, v247
    s_add_u32 m0, s48, 65536
    v_lshl_add_u64 v[4:5], v[6:7], 0, v[4:5]
    global_load_lds_dwordx4 v[4:5], off
    s_waitcnt lgkmcnt(4)
    v_mfma_f32_32x32x16_bf16 v[96:111], v[52:55], v[156:159], v[96:111]
    v_xor_b32 v13, 0x10000, v13
    v_xor_b32 v17, 0x10000, v17
    ds_read_b64_tr_b16 v[44:45], v13 offset:0
    v_mul_f32 v71, v71, v79
    v_fma_f32 v240, v240, v3, v3
    ds_read_b64_tr_b16 v[46:47], v13 offset:1024
    v_fma_f32 v241, v241, v3, v3
    v_fma_f32 v242, v242, v3, v3
    v_mfma_f32_32x32x16_bf16 v[112:127], v[56:59], v[156:159], v[112:127]
    ds_read_b64_tr_b16 v[48:49], v17 offset:0
    v_fma_f32 v243, v243, v3, v3
    v_fma_f32 v244, v244, v3, v3
    ds_read_b64_tr_b16 v[50:51], v17 offset:1024
    v_fma_f32 v245, v245, v3, v3
    v_fma_f32 v246, v246, v3, v3
    s_add_u32 m0, s48, 73728
    v_lshl_add_u64 v[4:5], v[6:7], 0, v[4:5]
    global_load_lds_dwordx4 v[4:5], off
    s_waitcnt lgkmcnt(4)
    v_mfma_f32_32x32x16_bf16 v[96:111], v[36:39], v[160:163], v[96:111]
    v_xor_b32 v14, 0x10000, v14
    v_xor_b32 v18, 0x10000, v18
    ds_read_b64_tr_b16 v[52:53], v14 offset:0
    v_fma_f32 v247, v247, v3, v3
    v_rcp_f32 v240, v240
    ds_read_b64_tr_b16 v[54:55], v14 offset:1024
    v_rcp_f32 v241, v241
    v_rcp_f32 v242, v242
    v_mfma_f32_32x32x16_bf16 v[112:127], v[40:43], v[160:163], v[112:127]
    ds_read_b64_tr_b16 v[56:57], v18 offset:0
    v_rcp_f32 v243, v243
    v_rcp_f32 v244, v244
    ds_read_b64_tr_b16 v[58:59], v18 offset:1024
    v_rcp_f32 v245, v245
    v_rcp_f32 v246, v246
    v_mfma_f32_16x16x32_bf16 v[28:31], v[24:27], v[36:39], v[28:31]
    v_mfma_f32_16x16x32_bf16 v[32:35], v[24:27], v[40:43], v[32:35]
    s_add_u32 m0, s48, 131072
    s_nop 0
    buffer_load_dwordx4 v2, s[40:43], s61 offen lds
    s_waitcnt lgkmcnt(4)
    v_mfma_f32_32x32x16_bf16 v[96:111], v[44:47], v[164:167], v[96:111]
    v_xor_b32 v15, 0x10000, v15
    v_xor_b32 v19, 0x10000, v19
    ds_read_b64_tr_b16 v[36:37], v15 offset:0
    v_rcp_f32 v247, v247
    v_mul_f32 v64, v64, v240
    ds_read_b64_tr_b16 v[38:39], v15 offset:1024
    v_mul_f32 v65, v65, v241
    v_mul_f32 v66, v66, v242
    v_mfma_f32_32x32x16_bf16 v[112:127], v[48:51], v[164:167], v[112:127]
    ds_read_b64_tr_b16 v[40:41], v19 offset:0
    v_mul_f32 v67, v67, v243
    v_mul_f32 v68, v68, v244
    ds_read_b64_tr_b16 v[42:43], v19 offset:1024
    v_mul_f32 v69, v69, v245
    v_mul_f32 v70, v70, v246
    s_waitcnt lgkmcnt(4)
    v_mfma_f32_32x32x16_bf16 v[96:111], v[52:55], v[168:171], v[96:111]
    ds_read_b64_tr_b16 v[44:45], v12 offset:16384
    v_mul_f32 v71, v71, v247
    v_cvt_pk_bf16_f32 v72, v64, v65
    ds_read_b64_tr_b16 v[46:47], v12 offset:17408
    v_cvt_pk_bf16_f32 v73, v66, v67
    v_cvt_pk_bf16_f32 v74, v68, v69
    v_mfma_f32_32x32x16_bf16 v[112:127], v[56:59], v[168:171], v[112:127]
    ds_read_b64_tr_b16 v[48:49], v16 offset:16384
    v_cvt_pk_bf16_f32 v75, v70, v71
    v_mul_f32 v240, v80, v80
    ds_read_b64_tr_b16 v[50:51], v16 offset:17408
    v_mul_f32 v241, v81, v81
    v_mul_f32 v242, v82, v82
    s_waitcnt lgkmcnt(4)
    v_mfma_f32_32x32x16_bf16 v[96:111], v[36:39], v[172:175], v[96:111]
    ds_read_b64_tr_b16 v[52:53], v13 offset:16384
    v_mul_f32 v243, v83, v83
    v_mul_f32 v244, v84, v84
    ds_read_b64_tr_b16 v[54:55], v13 offset:17408
    v_mul_f32 v245, v85, v85
    v_mul_f32 v246, v86, v86
    v_mfma_f32_32x32x16_bf16 v[112:127], v[40:43], v[172:175], v[112:127]
    ds_read_b64_tr_b16 v[56:57], v17 offset:16384
    v_mul_f32 v247, v87, v87
    v_fma_f32 v240, v240, v11, v10
    ds_read_b64_tr_b16 v[58:59], v17 offset:17408
    v_fma_f32 v241, v241, v11, v10
    v_fma_f32 v242, v242, v11, v10
    s_waitcnt lgkmcnt(4)
    v_mfma_f32_32x32x16_bf16 v[96:111], v[44:47], v[176:179], v[96:111]
    ds_read_b64_tr_b16 v[36:37], v14 offset:16384
    v_fma_f32 v243, v243, v11, v10
    v_fma_f32 v244, v244, v11, v10
    ds_read_b64_tr_b16 v[38:39], v14 offset:17408
    v_fma_f32 v245, v245, v11, v10
    v_fma_f32 v246, v246, v11, v10
    v_mfma_f32_32x32x16_bf16 v[112:127], v[48:51], v[176:179], v[112:127]
    ds_read_b64_tr_b16 v[40:41], v18 offset:16384
    v_fma_f32 v247, v247, v11, v10
    v_mul_f32 v240, v240, v80
    ds_read_b64_tr_b16 v[42:43], v18 offset:17408
    v_mul_f32 v241, v241, v81
    v_mul_f32 v242, v242, v82
    v_mfma_f32_16x16x32_bf16 v[28:31], v[24:27], v[44:47], v[28:31]
    v_mfma_f32_16x16x32_bf16 v[32:35], v[24:27], v[48:51], v[32:35]
    s_waitcnt lgkmcnt(4)
    v_mfma_f32_32x32x16_bf16 v[96:111], v[52:55], v[180:183], v[96:111]
    ds_read_b64_tr_b16 v[44:45], v15 offset:16384
    v_mul_f32 v243, v243, v83
    v_mul_f32 v244, v244, v84
    ds_read_b64_tr_b16 v[46:47], v15 offset:17408
    v_mul_f32 v245, v245, v85
    v_mul_f32 v246, v246, v86
    v_mfma_f32_32x32x16_bf16 v[112:127], v[56:59], v[180:183], v[112:127]
    ds_read_b64_tr_b16 v[48:49], v19 offset:16384
    v_mul_f32 v247, v247, v87
    v_exp_f32 v240, v240
    ds_read_b64_tr_b16 v[50:51], v19 offset:17408
    v_mul_f32 v80, v80, v88
    v_exp_f32 v241, v241
    s_waitcnt lgkmcnt(4)
    v_mfma_f32_32x32x16_bf16 v[96:111], v[36:39], v[184:187], v[96:111]
    s_waitcnt vmcnt(3)
    s_barrier
    ds_read_b64_tr_b16 v[52:53], v12 offset:32768
    v_mul_f32 v81, v81, v89
    v_exp_f32 v242, v242
    ds_read_b64_tr_b16 v[54:55], v12 offset:33792
    v_mul_f32 v82, v82, v90
    v_exp_f32 v243, v243
    v_mfma_f32_32x32x16_bf16 v[112:127], v[40:43], v[184:187], v[112:127]
    ds_read_b64_tr_b16 v[56:57], v16 offset:32768
    v_mul_f32 v83, v83, v91
    v_exp_f32 v244, v244
    ds_read_b64_tr_b16 v[58:59], v16 offset:33792
    v_mul_f32 v84, v84, v92
    v_exp_f32 v245, v245
    s_waitcnt lgkmcnt(4)
    v_mfma_f32_32x32x16_bf16 v[96:111], v[44:47], v[188:191], v[96:111]
    ds_read_b64_tr_b16 v[36:37], v13 offset:32768
    v_mul_f32 v85, v85, v93
    v_exp_f32 v246, v246
    ds_read_b64_tr_b16 v[38:39], v13 offset:33792
    v_mul_f32 v86, v86, v94
    v_exp_f32 v247, v247
    v_mfma_f32_32x32x16_bf16 v[112:127], v[48:51], v[188:191], v[112:127]
    ds_read_b64_tr_b16 v[40:41], v17 offset:32768
    v_mul_f32 v87, v87, v95
    v_fma_f32 v240, v240, v3, v3
    ds_read_b64_tr_b16 v[42:43], v17 offset:33792
    v_fma_f32 v241, v241, v3, v3
    s_waitcnt lgkmcnt(4)
    v_mfma_f32_32x32x16_bf16 v[96:111], v[52:55], v[192:195], v[96:111]
    ds_read_b64_tr_b16 v[44:45], v14 offset:32768
    v_fma_f32 v242, v242, v3, v3
    v_fma_f32 v243, v243, v3, v3
    ds_read_b64_tr_b16 v[46:47], v14 offset:33792
    v_fma_f32 v244, v244, v3, v3
    v_fma_f32 v245, v245, v3, v3
    v_mfma_f32_32x32x16_bf16 v[112:127], v[56:59], v[192:195], v[112:127]
    ds_read_b64_tr_b16 v[48:49], v18 offset:32768
    v_fma_f32 v246, v246, v3, v3
    v_fma_f32 v247, v247, v3, v3
    ds_read_b64_tr_b16 v[50:51], v18 offset:33792
    v_rcp_f32 v240, v240
    v_mfma_f32_16x16x32_bf16 v[28:31], v[24:27], v[52:55], v[28:31]
    v_mfma_f32_16x16x32_bf16 v[32:35], v[24:27], v[56:59], v[32:35]
    s_waitcnt lgkmcnt(4)
    v_mfma_f32_32x32x16_bf16 v[96:111], v[36:39], v[196:199], v[96:111]
    ds_read_b64_tr_b16 v[52:53], v15 offset:32768
    v_rcp_f32 v241, v241
    v_rcp_f32 v242, v242
    ds_read_b64_tr_b16 v[54:55], v15 offset:33792
    v_rcp_f32 v243, v243
    v_rcp_f32 v244, v244
    v_mfma_f32_32x32x16_bf16 v[112:127], v[40:43], v[196:199], v[112:127]
    ds_read_b64_tr_b16 v[56:57], v19 offset:32768
    v_rcp_f32 v245, v245
    v_rcp_f32 v246, v246
    ds_read_b64_tr_b16 v[58:59], v19 offset:33792
    v_rcp_f32 v247, v247
    s_waitcnt lgkmcnt(4)
    v_mfma_f32_32x32x16_bf16 v[96:111], v[44:47], v[200:203], v[96:111]
    ds_read_b64_tr_b16 v[36:37], v12 offset:49152
    v_mul_f32 v80, v80, v240
    v_mul_f32 v81, v81, v241
    ds_read_b64_tr_b16 v[38:39], v12 offset:50176
    v_mul_f32 v82, v82, v242
    v_mul_f32 v83, v83, v243
    v_mfma_f32_32x32x16_bf16 v[112:127], v[48:51], v[200:203], v[112:127]
    ds_read_b64_tr_b16 v[40:41], v16 offset:49152
    v_mul_f32 v84, v84, v244
    v_mul_f32 v85, v85, v245
    ds_read_b64_tr_b16 v[42:43], v16 offset:50176
    v_mul_f32 v86, v86, v246
    s_waitcnt lgkmcnt(4)
    v_mfma_f32_32x32x16_bf16 v[96:111], v[52:55], v[204:207], v[96:111]
    ds_read_b64_tr_b16 v[44:45], v13 offset:49152
    v_mul_f32 v87, v87, v247
    v_cvt_pk_bf16_f32 v88, v80, v81
    ds_read_b64_tr_b16 v[46:47], v13 offset:50176
    v_cvt_pk_bf16_f32 v89, v82, v83
    v_cvt_pk_bf16_f32 v90, v84, v85
    v_mfma_f32_32x32x16_bf16 v[112:127], v[56:59], v[204:207], v[112:127]
    ds_read_b64_tr_b16 v[48:49], v17 offset:49152
    v_cvt_pk_bf16_f32 v91, v86, v87
    buffer_store_dwordx4 v[72:75], v1, s[36:39], s10 offen sc1
    ds_read_b64_tr_b16 v[50:51], v17 offset:50176
    buffer_store_dwordx4 v[88:91], v1, s[36:39], s11 offen sc1
    s_waitcnt lgkmcnt(4)
    v_mfma_f32_32x32x16_bf16 v[96:111], v[36:39], v[208:211], v[96:111]
    ds_read_b64_tr_b16 v[52:53], v14 offset:49152
    ds_read_b64_tr_b16 v[54:55], v14 offset:50176
    v_mfma_f32_32x32x16_bf16 v[112:127], v[40:43], v[208:211], v[112:127]
    ds_read_b64_tr_b16 v[56:57], v18 offset:49152
    ds_read_b64_tr_b16 v[58:59], v18 offset:50176
    v_mfma_f32_16x16x32_bf16 v[28:31], v[24:27], v[36:39], v[28:31]
    v_mfma_f32_16x16x32_bf16 v[32:35], v[24:27], v[40:43], v[32:35]
    s_waitcnt lgkmcnt(4)
    v_mfma_f32_32x32x16_bf16 v[96:111], v[44:47], v[212:215], v[96:111]
    ds_read_b64_tr_b16 v[36:37], v15 offset:49152
    ds_read_b64_tr_b16 v[38:39], v15 offset:50176
    v_mfma_f32_32x32x16_bf16 v[112:127], v[48:51], v[212:215], v[112:127]
    ds_read_b64_tr_b16 v[40:41], v19 offset:49152
    ds_read_b64_tr_b16 v[42:43], v19 offset:50176
    s_waitcnt lgkmcnt(4)
    v_mfma_f32_32x32x16_bf16 v[96:111], v[52:55], v[216:219], v[96:111]
    s_waitcnt vmcnt(2)
    s_barrier
    v_xor_b32 v12, 0x10000, v12
    v_xor_b32 v16, 0x10000, v16
    ds_read_b64_tr_b16 v[44:45], v12 offset:0
    ds_read_b64_tr_b16 v[46:47], v12 offset:1024
    v_mfma_f32_32x32x16_bf16 v[112:127], v[56:59], v[216:219], v[112:127]
    ds_read_b64_tr_b16 v[48:49], v16 offset:0
    ds_read_b64_tr_b16 v[50:51], v16 offset:1024
    s_waitcnt lgkmcnt(4)
    v_mfma_f32_32x32x16_bf16 v[96:111], v[36:39], v[220:223], v[96:111]
    v_xor_b32 v13, 0x10000, v13
    v_xor_b32 v17, 0x10000, v17
    ds_read_b64_tr_b16 v[52:53], v13 offset:0
    v_lshrrev_b32 v250, 5, v0
    v_bfe_u32 v251, v0, 2, 2
    ds_read_b64_tr_b16 v[54:55], v13 offset:1024
    v_lshl_add_u32 v250, v250, 2, v251
    v_lshlrev_b32 v250, 7, v250
    v_bfe_u32 v251, v0, 4, 1
    v_lshl_add_u32 v250, v251, 5, v250
    v_mfma_f32_32x32x16_bf16 v[112:127], v[40:43], v[220:223], v[112:127]
    ds_read_b64_tr_b16 v[56:57], v17 offset:0
    v_and_b32 v251, 3, v0
    v_lshl_add_u32 v250, v251, 3, v250
    ds_read_b64_tr_b16 v[58:59], v17 offset:1024
    v_add_u32 v250, s47, v250
    ds_read_b64_tr_b16 v[252:253], v250
    ds_read_b64_tr_b16 v[254:255], v250 offset:1024
    s_waitcnt lgkmcnt(0)
    buffer_store_dwordx4 v[252:255], v1, s[36:39], s59 offen sc1
    v_mfma_f32_32x32x16_bf16 v[96:111], v[44:47], v[224:227], v[96:111]
    v_xor_b32 v14, 0x10000, v14
    v_xor_b32 v18, 0x10000, v18
    ds_read_b64_tr_b16 v[36:37], v14 offset:0
    ds_read_b64_tr_b16 v[38:39], v14 offset:1024
    v_mfma_f32_32x32x16_bf16 v[112:127], v[48:51], v[224:227], v[112:127]
    ds_read_b64_tr_b16 v[40:41], v18 offset:0
    ds_read_b64_tr_b16 v[42:43], v18 offset:1024
    v_mfma_f32_16x16x32_bf16 v[28:31], v[24:27], v[44:47], v[28:31]
    v_mfma_f32_16x16x32_bf16 v[32:35], v[24:27], v[48:51], v[32:35]
    v_mfma_f32_32x32x16_bf16 v[96:111], v[52:55], v[228:231], v[96:111]
    v_xor_b32 v15, 0x10000, v15
    v_xor_b32 v19, 0x10000, v19
    ds_read_b64_tr_b16 v[44:45], v15 offset:0
    s_nop 1
    s_mov_b64 exec, 0xffff
    ds_write_b32 v249, v28 offset:2048
    ds_write_b32 v249, v29 offset:2304
    ds_write_b32 v249, v32 offset:2560
    ds_write_b32 v249, v33 offset:2816
    s_mov_b64 exec, -1
    ds_read_b64_tr_b16 v[46:47], v15 offset:1024
    v_mfma_f32_32x32x16_bf16 v[112:127], v[56:59], v[228:231], v[112:127]
    ds_read_b64_tr_b16 v[48:49], v19 offset:0
    ds_read_b64_tr_b16 v[50:51], v19 offset:1024
    s_waitcnt lgkmcnt(8)
    v_mfma_f32_32x32x16_bf16 v[96:111], v[36:39], v[232:235], v[96:111]
    s_waitcnt lgkmcnt(3)
    s_barrier
    ds_read_b128 v[240:243], v248 offset:2048
    ds_read_b128 v[244:247], v248 offset:2560
    s_waitcnt lgkmcnt(0)
    v_add_f32 v240, v240, v241
    v_add_f32 v242, v242, v243
    v_add_f32 v244, v244, v245
    v_mfma_f32_32x32x16_bf16 v[112:127], v[40:43], v[232:235], v[112:127]
    v_add_f32 v246, v246, v247
    v_add_f32 v240, v240, v242
    v_add_f32 v244, v244, v246
    v_cvt_pk_bf16_f32 v241, v240, v240
    v_cvt_pk_bf16_f32 v245, v244, v244
    v_and_b32 v241, s49, v241
    s_cmp_eq_u32 s3, 0
    s_cbranch_scc0 pi_3
    s_and_b32 s6, s2, 15
    s_lshl_b32 s6, s6, 8
    s_add_u32 s6, s6, 13869056
    v_lshl_add_u32 v252, v0, 2, s6
    s_lshl_b32 s6, s4, 5
    s_add_u32 s6, s6, s62
    s_lshl_b32 s6, s6, 2
    s_add_u32 s6, s6, 13864960
    v_mov_b32 v254, s6
    buffer_load_dword v255, v254, s[36:39], 0 offen sc1
    buffer_load_dword v253, v252, s[36:39], 0 offen sc1
pi_3:
    v_mfma_f32_32x32x16_bf16 v[96:111], v[44:47], v[236:239], v[96:111]
    v_and_b32 v245, s49, v245
    v_sub_f32 v241, v240, v241
    v_sub_f32 v245, v244, v245
    v_cvt_pk_bf16_f32 v240, v240, v241
    v_cvt_pk_bf16_f32 v244, v244, v245
    v_cndmask_b32 v20, v240, 0, s[64:65]
    v_mfma_f32_32x32x16_bf16 v[112:127], v[48:51], v[236:239], v[112:127]
    v_cndmask_b32 v22, v244, 0, s[64:65]
    s_nop 1
    v_mfma_f32_32x32x16_bf16 v[96:111], v[20:23], v[60:63], v[96:111]
    v_mfma_f32_32x32x16_bf16 v[112:127], v[22:25], v[60:63], v[112:127]
    s_branch B_join
B_p2q:
    s_waitcnt lgkmcnt(4)
    v_mfma_f32_32x32x16_bf16 v[96:111], v[44:47], v[128:131], 0
    v_xor_b32 v14, 73728, v250
    v_xor_b32 v18, 73728, v251
    ds_read_b64_tr_b16 v[36:37], v14 offset:32768
    v_add_f32 v246, v246, v247
    v_add_f32 v240, v240, v242
    ds_read_b64_tr_b16 v[38:39], v14 offset:33792
    v_add_f32 v244, v244, v246
    v_cvt_pk_bf16_f32 v241, v240, v240
    v_cvt_pk_bf16_f32 v245, v244, v244
    v_and_b32 v241, s49, v241
    v_and_b32 v245, s49, v245
    v_sub_f32 v241, v240, v241
    v_sub_f32 v245, v244, v245
    v_cvt_pk_bf16_f32 v240, v240, v241
    v_cvt_pk_bf16_f32 v244, v244, v245
    v_cndmask_b32 v20, v240, 0, s[64:65]
    v_cndmask_b32 v22, v244, 0, s[64:65]
    s_nop 1
    v_mfma_f32_32x32x16_bf16 v[64:79], v[20:23], v[60:63], v[64:79]
    v_mfma_f32_32x32x16_bf16 v[80:95], v[22:25], v[60:63], v[80:95]
    v_mul_f32 v252, 1049335798, v8
    s_nop 9
    v_mul_f32 v240, v76, v8
    v_mul_f32 v241, v77, v8
    v_mfma_f32_32x32x16_bf16 v[112:127], v[48:51], v[128:131], 0
    ds_read_b64_tr_b16 v[40:41], v18 offset:32768
    v_mul_f32 v242, v78, v8
    v_mul_f32 v243, v79, v8
    ds_read_b64_tr_b16 v[42:43], v18 offset:33792
    v_mul_f32 v244, v92, v8
    v_mul_f32 v245, v93, v8
    v_mul_f32 v246, v94, v8
    v_mul_f32 v247, v95, v8
    v_cvt_pk_bf16_f32 v240, v240, v241
    v_cvt_pk_bf16_f32 v241, v242, v243
    v_cvt_pk_bf16_f32 v244, v244, v245
    v_cvt_pk_bf16_f32 v245, v246, v247
    s_cmp_eq_u32 s24, 3
    s_cbranch_scc0 nc_4
    v_mov_b32 v244, s16
    v_mov_b32 v245, s17
nc_4:
    s_mov_b64 exec, s[64:65]
    ds_write_b64 v253, v[240:241]
    ds_write_b64 v254, v[244:245]
    s_mov_b64 exec, -1
    v_mfma_f32_16x16x32_bf16 v[28:31], v[24:27], v[44:47], 0
    v_mfma_f32_16x16x32_bf16 v[32:35], v[24:27], v[48:51], 0
    s_add_u32 m0, s48, 49152
    v_lshl_add_u64 v[4:5], v[6:7], 0, v[4:5]
    global_load_lds_dwordx4 v[4:5], off
    s_waitcnt lgkmcnt(6)
    v_mfma_f32_32x32x16_bf16 v[96:111], v[52:55], v[132:135], v[96:111]
    s_waitcnt lgkmcnt(0)
    s_barrier
    v_xor_b32 v15, 77824, v250
    v_xor_b32 v19, 77824, v251
    ds_read_b64_tr_b16 v[44:45], v15 offset:32768
    s_cmp_eq_u32 s53, 0
    s_cbranch_scc0 kvs_5
    s_cmp_lt_u32 s62, 2
    s_cbranch_scc0 kvv_6
    ds_read2_b64 v[244:247], v255 offset0:0 offset1:2
    v_mov_b32 v242, v1
    s_branch kvt_7
kvv_6:
    ds_read_b64_tr_b16 v[244:245], v255
    ds_read_b64_tr_b16 v[246:247], v255 offset:256
    v_lshrrev_b32 v242, 4, v0
    v_and_b32 v241, 15, v0
    v_lshlrev_b32 v242, 9, v242
    v_lshl_add_u32 v242, v241, 4, v242
kvt_7:
    s_waitcnt lgkmcnt(0)
    buffer_store_dwordx4 v[244:247], v242, s[36:39], s25 offen sc1
kvs_5:
    v_mul_f32 v64, v64, v252
    ds_read_b64_tr_b16 v[46:47], v15 offset:33792
    v_mul_f32 v65, v65, v252
    v_mul_f32 v66, v66, v252
    v_mul_f32 v67, v67, v252
    v_mul_f32 v68, v68, v252
    v_mul_f32 v69, v69, v252
    v_mul_f32 v70, v70, v252
    v_mul_f32 v71, v71, v252
    v_mul_f32 v72, v72, v252
    v_mul_f32 v73, v73, v252
    v_mul_f32 v74, v74, v252
    v_mul_f32 v75, v75, v252
    v_mul_f32 v76, v76, v252
    v_mul_f32 v77, v77, v252
    v_mul_f32 v78, v78, v252
    v_mul_f32 v79, v79, v252
    v_cvt_pk_bf16_f32 v64, v64, v65
    v_cvt_pk_bf16_f32 v65, v66, v67
    v_cvt_pk_bf16_f32 v66, v68, v69
    v_mfma_f32_32x32x16_bf16 v[112:127], v[56:59], v[132:135], v[112:127]
    ds_read_b64_tr_b16 v[48:49], v19 offset:32768
    v_cvt_pk_bf16_f32 v67, v70, v71
    v_cvt_pk_bf16_f32 v68, v72, v73
    ds_read_b64_tr_b16 v[50:51], v19 offset:33792
    v_cvt_pk_bf16_f32 v69, v74, v75
    v_cvt_pk_bf16_f32 v70, v76, v77
    v_cvt_pk_bf16_f32 v71, v78, v79
    v_cndmask_b32 v70, v70, 0, s[64:65]
    v_cndmask_b32 v71, v71, 0, s[64:65]
    buffer_store_dwordx4 v[64:67], v1, s[36:39], s54 offen offset:0 sc1
    buffer_store_dwordx4 v[68:71], v1, s[36:39], s54 offen offset:1024 sc1
    v_mul_f32 v80, v80, v252
    v_mul_f32 v81, v81, v252
    v_mul_f32 v82, v82, v252
    v_mul_f32 v83, v83, v252
    v_mul_f32 v84, v84, v252
    v_mul_f32 v85, v85, v252
    v_mul_f32 v86, v86, v252
    v_mul_f32 v87, v87, v252
    v_mul_f32 v88, v88, v252
    v_mul_f32 v89, v89, v252
    v_mul_f32 v90, v90, v252
    s_add_u32 m0, s48, 57344
    v_lshl_add_u64 v[4:5], v[6:7], 0, v[4:5]
    global_load_lds_dwordx4 v[4:5], off
    v_mfma_f32_32x32x16_bf16 v[96:111], v[36:39], v[136:139], v[96:111]
    ds_read_b64_tr_b16 v[52:53], v12 offset:49152
    v_mul_f32 v91, v91, v252
    v_mul_f32 v92, v92, v252
    ds_read_b64_tr_b16 v[54:55], v12 offset:50176
    v_mul_f32 v93, v93, v252
    v_mul_f32 v94, v94, v252
    v_mul_f32 v95, v95, v252
    v_cvt_pk_bf16_f32 v80, v80, v81
    v_cvt_pk_bf16_f32 v81, v82, v83
    v_cvt_pk_bf16_f32 v82, v84, v85
    v_cvt_pk_bf16_f32 v83, v86, v87
    v_cvt_pk_bf16_f32 v84, v88, v89
    v_cvt_pk_bf16_f32 v85, v90, v91
    v_cvt_pk_bf16_f32 v86, v92, v93
    v_cvt_pk_bf16_f32 v87, v94, v95
    v_cndmask_b32 v86, v86, 0, s[64:65]
    v_cndmask_b32 v87, v87, 0, s[64:65]
    buffer_store_dwordx4 v[80:83], v1, s[36:39], s54 offen offset:2048 sc1
    buffer_store_dwordx4 v[84:87], v1, s[36:39], s54 offen offset:3072 sc1
    v_mfma_f32_32x32x16_bf16 v[112:127], v[40:43], v[136:139], v[112:127]
    ds_read_b64_tr_b16 v[56:57], v16 offset:49152
    ds_read_b64_tr_b16 v[58:59], v16 offset:50176
    s_waitcnt lgkmcnt(4)
    v_mfma_f32_32x32x16_bf16 v[96:111], v[44:47], v[140:143], v[96:111]
    ds_read_b64_tr_b16 v[36:37], v13 offset:49152
    ds_read_b64_tr_b16 v[38:39], v13 offset:50176
    v_mfma_f32_32x32x16_bf16 v[112:127], v[48:51], v[140:143], v[112:127]
    ds_read_b64_tr_b16 v[40:41], v17 offset:49152
    ds_read_b64_tr_b16 v[42:43], v17 offset:50176
    s_waitcnt lgkmcnt(4)
    v_mfma_f32_32x32x16_bf16 v[96:111], v[52:55], v[144:147], v[96:111]
    ds_read_b64_tr_b16 v[44:45], v14 offset:49152
    ds_read_b64_tr_b16 v[46:47], v14 offset:50176
    v_mfma_f32_32x32x16_bf16 v[112:127], v[56:59], v[144:147], v[112:127]
    ds_read_b64_tr_b16 v[48:49], v18 offset:49152
    ds_read_b64_tr_b16 v[50:51], v18 offset:50176
    v_mfma_f32_16x16x32_bf16 v[28:31], v[24:27], v[52:55], v[28:31]
    v_mfma_f32_16x16x32_bf16 v[32:35], v[24:27], v[56:59], v[32:35]
    s_waitcnt lgkmcnt(4)
    v_mfma_f32_32x32x16_bf16 v[96:111], v[36:39], v[148:151], v[96:111]
    ds_read_b64_tr_b16 v[52:53], v15 offset:49152
    ds_read_b64_tr_b16 v[54:55], v15 offset:50176
    v_mfma_f32_32x32x16_bf16 v[112:127], v[40:43], v[148:151], v[112:127]
    ds_read_b64_tr_b16 v[56:57], v19 offset:49152
    ds_read_b64_tr_b16 v[58:59], v19 offset:50176
    s_waitcnt lgkmcnt(4)
    v_mfma_f32_32x32x16_bf16 v[96:111], v[44:47], v[152:155], v[96:111]
    s_waitcnt vmcnt(5)
    s_waitcnt vmcnt(8)
    s_barrier
    s_cmp_eq_u32 s3, 0
    s_cbranch_scc0 fl_8
    s_lshl_b32 s6, s4, 2
    s_add_u32 s6, s6, s62
    s_lshl_b32 s6, s6, 2
    s_add_u32 s6, s6, 13869056
    v_lshlrev_b32 v250, 8, v0
    v_add_u32 v250, s6, v250
    v_mov_b32 v251, s58
    s_mov_b64 exec, 65535
    buffer_store_dword v251, v250, s[36:39], 0 offen sc1
    s_mov_b64 exec, -1
fl_8:
    v_xor_b32 v12, 0x10000, v12
    v_xor_b32 v16, 0x10000, v16
    ds_read_b64_tr_b16 v[36:37], v12 offset:0
    ds_read_b64_tr_b16 v[38:39], v12 offset:1024
    v_mfma_f32_32x32x16_bf16 v[112:127], v[48:51], v[152:155], v[112:127]
    ds_read_b64_tr_b16 v[40:41], v16 offset:0
    ds_read_b64_tr_b16 v[42:43], v16 offset:1024
    s_add_u32 m0, s48, 65536
    v_lshl_add_u64 v[4:5], v[6:7], 0, v[4:5]
    global_load_lds_dwordx4 v[4:5], off
    s_waitcnt lgkmcnt(4)
    v_mfma_f32_32x32x16_bf16 v[96:111], v[52:55], v[156:159], v[96:111]
    v_xor_b32 v13, 0x10000, v13
    v_xor_b32 v17, 0x10000, v17
    ds_read_b64_tr_b16 v[44:45], v13 offset:0
    ds_read_b64_tr_b16 v[46:47], v13 offset:1024
    v_mfma_f32_32x32x16_bf16 v[112:127], v[56:59], v[156:159], v[112:127]
    ds_read_b64_tr_b16 v[48:49], v17 offset:0
    ds_read_b64_tr_b16 v[50:51], v17 offset:1024
    s_add_u32 m0, s48, 73728
    v_lshl_add_u64 v[4:5], v[6:7], 0, v[4:5]
    global_load_lds_dwordx4 v[4:5], off
    s_waitcnt lgkmcnt(4)
    v_mfma_f32_32x32x16_bf16 v[96:111], v[36:39], v[160:163], v[96:111]
    v_xor_b32 v14, 0x10000, v14
    v_xor_b32 v18, 0x10000, v18
    ds_read_b64_tr_b16 v[52:53], v14 offset:0
    ds_read_b64_tr_b16 v[54:55], v14 offset:1024
    v_mfma_f32_32x32x16_bf16 v[112:127], v[40:43], v[160:163], v[112:127]
    ds_read_b64_tr_b16 v[56:57], v18 offset:0
    ds_read_b64_tr_b16 v[58:59], v18 offset:1024
    v_mfma_f32_16x16x32_bf16 v[28:31], v[24:27], v[36:39], v[28:31]
    v_mfma_f32_16x16x32_bf16 v[32:35], v[24:27], v[40:43], v[32:35]
    s_add_u32 m0, s48, 131072
    s_nop 0
    buffer_load_dwordx4 v2, s[40:43], s61 offen lds
    s_waitcnt lgkmcnt(4)
    v_mfma_f32_32x32x16_bf16 v[96:111], v[44:47], v[164:167], v[96:111]
    v_xor_b32 v15, 0x10000, v15
    v_xor_b32 v19, 0x10000, v19
    ds_read_b64_tr_b16 v[36:37], v15 offset:0
    ds_read_b64_tr_b16 v[38:39], v15 offset:1024
    v_mfma_f32_32x32x16_bf16 v[112:127], v[48:51], v[164:167], v[112:127]
    ds_read_b64_tr_b16 v[40:41], v19 offset:0
    ds_read_b64_tr_b16 v[42:43], v19 offset:1024
    s_waitcnt lgkmcnt(4)
    v_mfma_f32_32x32x16_bf16 v[96:111], v[52:55], v[168:171], v[96:111]
    ds_read_b64_tr_b16 v[44:45], v12 offset:16384
    ds_read_b64_tr_b16 v[46:47], v12 offset:17408
    v_mfma_f32_32x32x16_bf16 v[112:127], v[56:59], v[168:171], v[112:127]
    ds_read_b64_tr_b16 v[48:49], v16 offset:16384
    ds_read_b64_tr_b16 v[50:51], v16 offset:17408
    s_waitcnt lgkmcnt(4)
    v_mfma_f32_32x32x16_bf16 v[96:111], v[36:39], v[172:175], v[96:111]
    ds_read_b64_tr_b16 v[52:53], v13 offset:16384
    ds_read_b64_tr_b16 v[54:55], v13 offset:17408
    v_mfma_f32_32x32x16_bf16 v[112:127], v[40:43], v[172:175], v[112:127]
    ds_read_b64_tr_b16 v[56:57], v17 offset:16384
    ds_read_b64_tr_b16 v[58:59], v17 offset:17408
    s_waitcnt lgkmcnt(4)
    v_mfma_f32_32x32x16_bf16 v[96:111], v[44:47], v[176:179], v[96:111]
    ds_read_b64_tr_b16 v[36:37], v14 offset:16384
    ds_read_b64_tr_b16 v[38:39], v14 offset:17408
    v_mfma_f32_32x32x16_bf16 v[112:127], v[48:51], v[176:179], v[112:127]
    ds_read_b64_tr_b16 v[40:41], v18 offset:16384
    ds_read_b64_tr_b16 v[42:43], v18 offset:17408
    v_mfma_f32_16x16x32_bf16 v[28:31], v[24:27], v[44:47], v[28:31]
    v_mfma_f32_16x16x32_bf16 v[32:35], v[24:27], v[48:51], v[32:35]
    s_waitcnt lgkmcnt(4)
    v_mfma_f32_32x32x16_bf16 v[96:111], v[52:55], v[180:183], v[96:111]
    ds_read_b64_tr_b16 v[44:45], v15 offset:16384
    ds_read_b64_tr_b16 v[46:47], v15 offset:17408
    v_mfma_f32_32x32x16_bf16 v[112:127], v[56:59], v[180:183], v[112:127]
    ds_read_b64_tr_b16 v[48:49], v19 offset:16384
    ds_read_b64_tr_b16 v[50:51], v19 offset:17408
    s_waitcnt lgkmcnt(4)
    v_mfma_f32_32x32x16_bf16 v[96:111], v[36:39], v[184:187], v[96:111]
    s_waitcnt vmcnt(3)
    s_barrier
    s_cmp_eq_u32 s3, 0
    s_cbranch_scc0 fl_9
    s_lshl_b32 s6, s4, 5
    s_add_u32 s6, s6, s62
    s_lshl_b32 s6, s6, 2
    s_add_u32 s6, s6, 13864960
    v_mov_b32 v250, s6
    v_mov_b32 v251, s58
    s_mov_b64 exec, 1
    buffer_store_dword v251, v250, s[36:39], 0 offen sc1
    s_mov_b64 exec, -1
fl_9:
    ds_read_b64_tr_b16 v[52:53], v12 offset:32768
    ds_read_b64_tr_b16 v[54:55], v12 offset:33792
    v_mfma_f32_32x32x16_bf16 v[112:127], v[40:43], v[184:187], v[112:127]
    ds_read_b64_tr_b16 v[56:57], v16 offset:32768
    ds_read_b64_tr_b16 v[58:59], v16 offset:33792
    s_waitcnt lgkmcnt(4)
    v_mfma_f32_32x32x16_bf16 v[96:111], v[44:47], v[188:191], v[96:111]
    ds_read_b64_tr_b16 v[36:37], v13 offset:32768
    ds_read_b64_tr_b16 v[38:39], v13 offset:33792
    v_mfma_f32_32x32x16_bf16 v[112:127], v[48:51], v[188:191], v[112:127]
    ds_read_b64_tr_b16 v[40:41], v17 offset:32768
    ds_read_b64_tr_b16 v[42:43], v17 offset:33792
    s_waitcnt lgkmcnt(4)
    v_mfma_f32_32x32x16_bf16 v[96:111], v[52:55], v[192:195], v[96:111]
    ds_read_b64_tr_b16 v[44:45], v14 offset:32768
    ds_read_b64_tr_b16 v[46:47], v14 offset:33792
    v_mfma_f32_32x32x16_bf16 v[112:127], v[56:59], v[192:195], v[112:127]
    ds_read_b64_tr_b16 v[48:49], v18 offset:32768
    ds_read_b64_tr_b16 v[50:51], v18 offset:33792
    v_mfma_f32_16x16x32_bf16 v[28:31], v[24:27], v[52:55], v[28:31]
    v_mfma_f32_16x16x32_bf16 v[32:35], v[24:27], v[56:59], v[32:35]
    s_waitcnt lgkmcnt(4)
    v_mfma_f32_32x32x16_bf16 v[96:111], v[36:39], v[196:199], v[96:111]
    ds_read_b64_tr_b16 v[52:53], v15 offset:32768
    ds_read_b64_tr_b16 v[54:55], v15 offset:33792
    v_mfma_f32_32x32x16_bf16 v[112:127], v[40:43], v[196:199], v[112:127]
    ds_read_b64_tr_b16 v[56:57], v19 offset:32768
    ds_read_b64_tr_b16 v[58:59], v19 offset:33792
    s_waitcnt lgkmcnt(4)
    v_mfma_f32_32x32x16_bf16 v[96:111], v[44:47], v[200:203], v[96:111]
    ds_read_b64_tr_b16 v[36:37], v12 offset:49152
    ds_read_b64_tr_b16 v[38:39], v12 offset:50176
    v_mfma_f32_32x32x16_bf16 v[112:127], v[48:51], v[200:203], v[112:127]
    ds_read_b64_tr_b16 v[40:41], v16 offset:49152
    ds_read_b64_tr_b16 v[42:43], v16 offset:50176
    s_waitcnt lgkmcnt(4)
    v_mfma_f32_32x32x16_bf16 v[96:111], v[52:55], v[204:207], v[96:111]
    ds_read_b64_tr_b16 v[44:45], v13 offset:49152
    ds_read_b64_tr_b16 v[46:47], v13 offset:50176
    v_mfma_f32_32x32x16_bf16 v[112:127], v[56:59], v[204:207], v[112:127]
    ds_read_b64_tr_b16 v[48:49], v17 offset:49152
    ds_read_b64_tr_b16 v[50:51], v17 offset:50176
    s_waitcnt lgkmcnt(4)
    v_mfma_f32_32x32x16_bf16 v[96:111], v[36:39], v[208:211], v[96:111]
    ds_read_b64_tr_b16 v[52:53], v14 offset:49152
    ds_read_b64_tr_b16 v[54:55], v14 offset:50176
    v_mfma_f32_32x32x16_bf16 v[112:127], v[40:43], v[208:211], v[112:127]
    ds_read_b64_tr_b16 v[56:57], v18 offset:49152
    ds_read_b64_tr_b16 v[58:59], v18 offset:50176
    v_mfma_f32_16x16x32_bf16 v[28:31], v[24:27], v[36:39], v[28:31]
    v_mfma_f32_16x16x32_bf16 v[32:35], v[24:27], v[40:43], v[32:35]
    s_waitcnt lgkmcnt(4)
    v_mfma_f32_32x32x16_bf16 v[96:111], v[44:47], v[212:215], v[96:111]
    ds_read_b64_tr_b16 v[36:37], v15 offset:49152
    ds_read_b64_tr_b16 v[38:39], v15 offset:50176
    v_mfma_f32_32x32x16_bf16 v[112:127], v[48:51], v[212:215], v[112:127]
    ds_read_b64_tr_b16 v[40:41], v19 offset:49152
    ds_read_b64_tr_b16 v[42:43], v19 offset:50176
    s_waitcnt lgkmcnt(4)
    v_mfma_f32_32x32x16_bf16 v[96:111], v[52:55], v[216:219], v[96:111]
    s_waitcnt vmcnt(0)
    s_barrier
    v_xor_b32 v12, 0x10000, v12
    v_xor_b32 v16, 0x10000, v16
    ds_read_b64_tr_b16 v[44:45], v12 offset:0
    ds_read_b64_tr_b16 v[46:47], v12 offset:1024
    v_mfma_f32_32x32x16_bf16 v[112:127], v[56:59], v[216:219], v[112:127]
    ds_read_b64_tr_b16 v[48:49], v16 offset:0
    ds_read_b64_tr_b16 v[50:51], v16 offset:1024
    s_waitcnt lgkmcnt(4)
    v_mfma_f32_32x32x16_bf16 v[96:111], v[36:39], v[220:223], v[96:111]
    v_xor_b32 v13, 0x10000, v13
    v_xor_b32 v17, 0x10000, v17
    ds_read_b64_tr_b16 v[52:53], v13 offset:0
    v_lshrrev_b32 v250, 5, v0
    v_bfe_u32 v251, v0, 2, 2
    ds_read_b64_tr_b16 v[54:55], v13 offset:1024
    v_lshl_add_u32 v250, v250, 2, v251
    v_lshlrev_b32 v250, 7, v250
    v_bfe_u32 v251, v0, 4, 1
    v_lshl_add_u32 v250, v251, 5, v250
    v_mfma_f32_32x32x16_bf16 v[112:127], v[40:43], v[220:223], v[112:127]
    ds_read_b64_tr_b16 v[56:57], v17 offset:0
    v_and_b32 v251, 3, v0
    v_lshl_add_u32 v250, v251, 3, v250
    ds_read_b64_tr_b16 v[58:59], v17 offset:1024
    v_add_u32 v250, s47, v250
    ds_read_b64_tr_b16 v[252:253], v250
    ds_read_b64_tr_b16 v[254:255], v250 offset:1024
    s_waitcnt lgkmcnt(0)
    buffer_store_dwordx4 v[252:255], v1, s[36:39], s59 offen sc1
    v_mfma_f32_32x32x16_bf16 v[96:111], v[44:47], v[224:227], v[96:111]
    v_xor_b32 v14, 0x10000, v14
    v_xor_b32 v18, 0x10000, v18
    ds_read_b64_tr_b16 v[36:37], v14 offset:0
    ds_read_b64_tr_b16 v[38:39], v14 offset:1024
    v_mfma_f32_32x32x16_bf16 v[112:127], v[48:51], v[224:227], v[112:127]
    ds_read_b64_tr_b16 v[40:41], v18 offset:0
    ds_read_b64_tr_b16 v[42:43], v18 offset:1024
    v_mfma_f32_16x16x32_bf16 v[28:31], v[24:27], v[44:47], v[28:31]
    v_mfma_f32_16x16x32_bf16 v[32:35], v[24:27], v[48:51], v[32:35]
    v_mfma_f32_32x32x16_bf16 v[96:111], v[52:55], v[228:231], v[96:111]
    v_xor_b32 v15, 0x10000, v15
    v_xor_b32 v19, 0x10000, v19
    ds_read_b64_tr_b16 v[44:45], v15 offset:0
    s_nop 1
    s_mov_b64 exec, 0xffff
    ds_write_b32 v249, v28 offset:2048
    ds_write_b32 v249, v29 offset:2304
    ds_write_b32 v249, v32 offset:2560
    ds_write_b32 v249, v33 offset:2816
    s_mov_b64 exec, -1
    ds_read_b64_tr_b16 v[46:47], v15 offset:1024
    v_mfma_f32_32x32x16_bf16 v[112:127], v[56:59], v[228:231], v[112:127]
    ds_read_b64_tr_b16 v[48:49], v19 offset:0
    ds_read_b64_tr_b16 v[50:51], v19 offset:1024
    s_waitcnt lgkmcnt(8)
    v_mfma_f32_32x32x16_bf16 v[96:111], v[36:39], v[232:235], v[96:111]
    s_waitcnt lgkmcnt(3)
    s_barrier
    ds_read_b128 v[240:243], v248 offset:2048
    ds_read_b128 v[244:247], v248 offset:2560
    s_waitcnt lgkmcnt(0)
    v_add_f32 v240, v240, v241
    v_add_f32 v242, v242, v243
    v_add_f32 v244, v244, v245
    v_mfma_f32_32x32x16_bf16 v[112:127], v[40:43], v[232:235], v[112:127]
    v_add_f32 v246, v246, v247
    v_add_f32 v240, v240, v242
    v_add_f32 v244, v244, v246
    v_cvt_pk_bf16_f32 v241, v240, v240
    v_cvt_pk_bf16_f32 v245, v244, v244
    v_and_b32 v241, s49, v241
    s_cmp_eq_u32 s3, 0
    s_cbranch_scc0 pi_10
    s_and_b32 s6, s2, 15
    s_lshl_b32 s6, s6, 8
    s_add_u32 s6, s6, 13869056
    v_lshl_add_u32 v252, v0, 2, s6
    s_lshl_b32 s6, s4, 5
    s_add_u32 s6, s6, s62
    s_lshl_b32 s6, s6, 2
    s_add_u32 s6, s6, 13864960
    v_mov_b32 v254, s6
    buffer_load_dword v255, v254, s[36:39], 0 offen sc1
    buffer_load_dword v253, v252, s[36:39], 0 offen sc1
pi_10:
    v_mfma_f32_32x32x16_bf16 v[96:111], v[44:47], v[236:239], v[96:111]
    v_and_b32 v245, s49, v245
    v_sub_f32 v241, v240, v241
    v_sub_f32 v245, v244, v245
    v_cvt_pk_bf16_f32 v240, v240, v241
    v_cvt_pk_bf16_f32 v244, v244, v245
    v_cndmask_b32 v20, v240, 0, s[64:65]
    v_mfma_f32_32x32x16_bf16 v[112:127], v[48:51], v[236:239], v[112:127]
    v_cndmask_b32 v22, v244, 0, s[64:65]
    s_nop 1
    v_mfma_f32_32x32x16_bf16 v[96:111], v[20:23], v[60:63], v[96:111]
    v_mfma_f32_32x32x16_bf16 v[112:127], v[22:25], v[60:63], v[112:127]
B_join:
    s_cmp_eq_u32 s3, 0
    s_cbranch_scc0 pok_11
    s_waitcnt vmcnt(0)
    v_cmp_ne_u32 vcc, s58, v253
    s_cbranch_vccz pok_11
    s_mov_b32 s74, 2097152
psp_12:
    s_sleep 1
    buffer_load_dword v253, v252, s[36:39], 0 offen sc1
    s_sub_u32 s74, s74, 1
    s_waitcnt vmcnt(0)
    v_cmp_ne_u32 vcc, s58, v253
    s_cmp_eq_u32 s74, 0
    s_cbranch_scc1 pok_11
    s_cbranch_vccnz psp_12
pok_11:
    s_cmp_eq_u32 s3, 0
    s_cbranch_scc0 pok_13
    s_waitcnt vmcnt(0)
    v_cmp_ne_u32 vcc, s58, v255
    s_cbranch_vccz pok_13
    s_mov_b32 s74, 2097152
psp_14:
    s_sleep 1
    buffer_load_dword v255, v254, s[36:39], 0 offen sc1
    s_sub_u32 s74, s74, 1
    s_waitcnt vmcnt(0)
    v_cmp_ne_u32 vcc, s58, v255
    s_cmp_eq_u32 s74, 0
    s_cbranch_scc1 pok_13
    s_cbranch_vccnz psp_14
pok_13:
    s_waitcnt vmcnt(0)
    s_barrier
    s_cmp_eq_u32 s3, 0
    s_cbranch_scc0 fl_15
    s_lshl_b32 s6, s4, 5
    s_add_u32 s6, s6, s5
    s_lshl_b32 s6, s6, 2
    s_add_u32 s6, s6, 13862976
    s_lshl_b32 s66, s46, 2
    s_add_u32 s66, s66, 13860864
    s_sub_u32 s66, s66, s6
    v_mul_lo_u32 v252, v0, s66
    v_add_u32 v252, s6, v252
    v_mov_b32 v253, s58
    s_mov_b64 exec, 3
    buffer_store_dword v253, v252, s[36:39], 0 offen sc1
    s_mov_b64 exec, -1
fl_15:
    s_add_u32 m0, s18, 98304
    s_nop 0
    buffer_load_dwordx4 v1, s[36:39], s15 offen offset:0 sc1 lds
    buffer_load_dwordx4 v1, s[36:39], s15 offen offset:1024 sc1 lds
    buffer_load_dwordx4 v1, s[36:39], s15 offen offset:2048 sc1 lds
    buffer_load_dwordx4 v1, s[36:39], s15 offen offset:3072 sc1 lds
    s_add_u32 s15, s15, 16384
    buffer_load_dwordx4 v[36:39], v1, s[36:39], s14 offen sc1
    buffer_load_dwordx4 v[40:43], v1, s[36:39], s14 offen offset:1024 sc1
    v_mul_f32 v240, v96, v96
    v_mul_f32 v248, v112, v112
    v_mul_f32 v241, v97, v97
    v_mul_f32 v249, v113, v113
    v_mul_f32 v242, v98, v98
    v_mul_f32 v250, v114, v114
    v_mul_f32 v243, v99, v99
    v_mul_f32 v251, v115, v115
    v_mul_f32 v244, v100, v100
    v_mul_f32 v252, v116, v116
    v_mul_f32 v245, v101, v101
    v_mul_f32 v253, v117, v117
    v_mul_f32 v246, v102, v102
    v_mul_f32 v254, v118, v118
    v_mul_f32 v247, v103, v103
    v_mul_f32 v255, v119, v119
    v_fma_f32 v240, v240, v11, v10
    v_fma_f32 v248, v248, v11, v10
    v_fma_f32 v241, v241, v11, v10
    v_fma_f32 v249, v249, v11, v10
    v_fma_f32 v242, v242, v11, v10
    v_fma_f32 v250, v250, v11, v10
    v_fma_f32 v243, v243, v11, v10
    v_fma_f32 v251, v251, v11, v10
    v_fma_f32 v244, v244, v11, v10
    v_fma_f32 v252, v252, v11, v10
    v_fma_f32 v245, v245, v11, v10
    v_fma_f32 v253, v253, v11, v10
    v_fma_f32 v246, v246, v11, v10
    v_fma_f32 v254, v254, v11, v10
    v_fma_f32 v247, v247, v11, v10
    v_fma_f32 v255, v255, v11, v10
    v_mul_f32 v240, v240, v96
    v_mul_f32 v248, v248, v112
    v_mul_f32 v241, v241, v97
    v_mul_f32 v249, v249, v113
    v_mul_f32 v242, v242, v98
    v_mul_f32 v250, v250, v114
    v_mul_f32 v243, v243, v99
    v_mul_f32 v251, v251, v115
    v_mul_f32 v244, v244, v100
    v_mul_f32 v252, v252, v116
    v_mul_f32 v245, v245, v101
    v_mul_f32 v253, v253, v117
    v_mul_f32 v246, v246, v102
    v_mul_f32 v254, v254, v118
    v_mul_f32 v247, v247, v103
    v_mul_f32 v255, v255, v119
    v_exp_f32 v240, v240
    v_exp_f32 v248, v248
    v_mul_f32 v96, v96, v104
    v_mul_f32 v112, v112, v120
    v_exp_f32 v241, v241
    v_exp_f32 v249, v249
    v_mul_f32 v97, v97, v105
    v_mul_f32 v113, v113, v121
    v_exp_f32 v242, v242
    v_exp_f32 v250, v250
    v_mul_f32 v98, v98, v106
    v_mul_f32 v114, v114, v122
    v_exp_f32 v243, v243
    v_exp_f32 v251, v251
    v_mul_f32 v99, v99, v107
    v_mul_f32 v115, v115, v123
    v_exp_f32 v244, v244
    v_exp_f32 v252, v252
    v_mul_f32 v100, v100, v108
    v_mul_f32 v116, v116, v124
    v_exp_f32 v245, v245
    v_exp_f32 v253, v253
    v_mul_f32 v101, v101, v109
    v_mul_f32 v117, v117, v125
    v_exp_f32 v246, v246
    v_exp_f32 v254, v254
    v_mul_f32 v102, v102, v110
    v_mul_f32 v118, v118, v126
    v_exp_f32 v247, v247
    v_exp_f32 v255, v255
    v_mul_f32 v103, v103, v111
    v_mul_f32 v119, v119, v127
    v_fma_f32 v240, v240, v3, v3
    v_fma_f32 v248, v248, v3, v3
    v_fma_f32 v241, v241, v3, v3
    v_fma_f32 v249, v249, v3, v3
    v_fma_f32 v242, v242, v3, v3
    v_fma_f32 v250, v250, v3, v3
    v_fma_f32 v243, v243, v3, v3
    v_fma_f32 v251, v251, v3, v3
    v_fma_f32 v244, v244, v3, v3
    v_fma_f32 v252, v252, v3, v3
    v_fma_f32 v245, v245, v3, v3
    v_fma_f32 v253, v253, v3, v3
    v_fma_f32 v246, v246, v3, v3
    v_fma_f32 v254, v254, v3, v3
    v_fma_f32 v247, v247, v3, v3
    v_fma_f32 v255, v255, v3, v3
    v_rcp_f32 v240, v240
    v_rcp_f32 v248, v248
    v_rcp_f32 v241, v241
    v_rcp_f32 v249, v249
    v_rcp_f32 v242, v242
    v_rcp_f32 v250, v250
    v_rcp_f32 v243, v243
    v_rcp_f32 v251, v251
    v_rcp_f32 v244, v244
    v_rcp_f32 v252, v252
    v_rcp_f32 v245, v245
    v_rcp_f32 v253, v253
    v_rcp_f32 v246, v246
    v_rcp_f32 v254, v254
    v_rcp_f32 v247, v247
    v_rcp_f32 v255, v255
    v_mul_f32 v96, v96, v240
    v_mul_f32 v112, v112, v248
    v_mul_f32 v97, v97, v241
    v_mul_f32 v113, v113, v249
    v_mul_f32 v98, v98, v242
    v_mul_f32 v114, v114, v250
    v_mul_f32 v99, v99, v243
    v_mul_f32 v115, v115, v251
    v_mul_f32 v100, v100, v244
    v_mul_f32 v116, v116, v252
    v_mul_f32 v101, v101, v245
    v_mul_f32 v117, v117, v253
    v_mul_f32 v102, v102, v246
    v_mul_f32 v118, v118, v254
    v_mul_f32 v103, v103, v247
    v_mul_f32 v119, v119, v255
    v_cvt_pk_bf16_f32 v16, v96, v97
    v_cvt_pk_bf16_f32 v20, v112, v113
    v_cvt_pk_bf16_f32 v17, v98, v99
    v_cvt_pk_bf16_f32 v21, v114, v115
    v_cvt_pk_bf16_f32 v18, v100, v101
    v_cvt_pk_bf16_f32 v22, v116, v117
    v_cvt_pk_bf16_f32 v19, v102, v103
    v_cvt_pk_bf16_f32 v23, v118, v119
    s_add_u32 m0, s18, 0
    s_nop 0
    buffer_load_dwordx4 v1, s[36:39], s15 offen offset:0 sc1 lds
    buffer_load_dwordx4 v1, s[36:39], s15 offen offset:1024 sc1 lds
    buffer_load_dwordx4 v1, s[36:39], s15 offen offset:2048 sc1 lds
    buffer_load_dwordx4 v1, s[36:39], s15 offen offset:3072 sc1 lds
    s_add_u32 s15, s15, 16384
    s_lshl_b32 s6, s53, 14
    v_add_u32 v3, s6, v1
    v_add_u32 v4, 0x10000, v3
    s_and_b32 s6, s5, 7
    s_cmp_eq_u32 s6, 7
    s_cbranch_scc1 C_noF
    s_cmp_ge_u32 s3, 4
    s_cbranch_scc0 np_16
    s_setprio 1
np_16:
    s_waitcnt vmcnt(4)
    s_barrier
    ds_read_b128 v[104:107], v4 offset:32768
    ds_read_b128 v[108:111], v4 offset:33792
    ds_read_b128 v[112:115], v4 offset:34816
    s_waitcnt lgkmcnt(1)
    v_mfma_f32_32x32x16_bf16 v[64:79], v[104:107], v[36:39], 0
    v_mfma_f32_32x32x16_bf16 v[64:79], v[108:111], v[40:43], v[64:79]
    ds_read_b128 v[104:107], v4 offset:36864
    ds_read_b128 v[108:111], v4 offset:37888
    s_nop 9
    v_exp_f32 v64, v64
    v_exp_f32 v65, v65
    s_waitcnt lgkmcnt(0)
    ds_read_b128 v[120:123], v4 offset:35840
    v_exp_f32 v66, v66
    v_exp_f32 v67, v67
    v_exp_f32 v68, v68
    s_cmp_eq_u32 s3, 0
    s_cbranch_scc0 pi_17
    s_lshl_b32 s6, s4, 7
    s_add_u32 s6, s6, 13862976
    s_and_b32 s7, s5, 7
    s_lshl_b32 s7, s7, 8
    s_add_u32 s7, s7, 13860800
    v_lshl_add_u32 v240, v0, 2, s6
    v_lshl_add_u32 v241, v0, 2, s7
    v_mov_b32 v242, s6
    s_mov_b32 s66, 0xffff0000
    s_mov_b32 s67, 0x00000fff
    s_mov_b32 s68, 0x00008888
    s_mov_b32 s69, 0xfffff000
    v_cndmask_b32 v240, v240, v241, s[66:67]
    v_cndmask_b32 v240, v240, v242, s[68:69]
    buffer_load_dword v241, v240, s[36:39], 0 offen sc1
pi_17:
    v_cvt_pk_bf16_f32 v96, v64, v65
    v_cvt_pk_bf16_f32 v97, v66, v67
    v_exp_f32 v69, v69
    v_exp_f32 v70, v70
    v_mfma_f32_32x32x16_bf16 v[80:95], v[104:107], v[36:39], 0
    ds_read_b128 v[116:119], v4 offset:38912
    v_exp_f32 v71, v71
    v_exp_f32 v72, v72
    v_exp_f32 v73, v73
    v_mfma_f32_32x32x16_bf16 v[80:95], v[108:111], v[40:43], v[80:95]
    ds_read_b128 v[104:107], v4 offset:40960
    ds_read_b128 v[108:111], v4 offset:41984
    s_add_u32 m0, s18, 32768
    s_nop 0
    v_cvt_pk_bf16_f32 v98, v68, v69
    v_cvt_pk_bf16_f32 v99, v70, v71
    v_exp_f32 v74, v74
    v_exp_f32 v75, v75
    v_exp_f32 v76, v76
    v_exp_f32 v77, v77
    v_cvt_pk_bf16_f32 v100, v72, v73
    v_cvt_pk_bf16_f32 v101, v74, v75
    v_mfma_f32_32x32x16_bf16 v[44:59], v[112:115], v[96:99], 0
    buffer_load_dwordx4 v1, s[36:39], s15 offen offset:0 sc1 lds
    buffer_load_dwordx4 v1, s[36:39], s15 offen offset:1024 sc1 lds
    v_exp_f32 v78, v78
    v_exp_f32 v79, v79
    v_cvt_pk_bf16_f32 v102, v76, v77
    v_cvt_pk_bf16_f32 v103, v78, v79
    v_exp_f32 v80, v80
    v_exp_f32 v81, v81
    s_waitcnt lgkmcnt(0)
    v_mfma_f32_32x32x16_bf16 v[44:59], v[120:123], v[100:103], v[44:59]
    ds_read_b128 v[120:123], v4 offset:39936
    v_exp_f32 v82, v82
    v_exp_f32 v83, v83
    v_exp_f32 v84, v84
    v_cvt_pk_bf16_f32 v96, v80, v81
    v_cvt_pk_bf16_f32 v97, v82, v83
    v_exp_f32 v85, v85
    v_exp_f32 v86, v86
    v_mfma_f32_32x32x16_bf16 v[64:79], v[104:107], v[36:39], 0
    ds_read_b128 v[112:115], v4 offset:43008
    v_exp_f32 v87, v87
    v_exp_f32 v88, v88
    v_exp_f32 v89, v89
    v_mfma_f32_32x32x16_bf16 v[64:79], v[108:111], v[40:43], v[64:79]
    ds_read_b128 v[104:107], v4 offset:45056
    ds_read_b128 v[108:111], v4 offset:46080
    v_cvt_pk_bf16_f32 v98, v84, v85
    v_cvt_pk_bf16_f32 v99, v86, v87
    v_exp_f32 v90, v90
    v_exp_f32 v91, v91
    v_exp_f32 v92, v92
    v_exp_f32 v93, v93
    v_cvt_pk_bf16_f32 v100, v88, v89
    v_cvt_pk_bf16_f32 v101, v90, v91
    v_mfma_f32_32x32x16_bf16 v[44:59], v[116:119], v[96:99], v[44:59]
    buffer_load_dwordx4 v1, s[36:39], s15 offen offset:2048 sc1 lds
    buffer_load_dwordx4 v1, s[36:39], s15 offen offset:3072 sc1 lds
    s_add_u32 s15, s15, 16384
    buffer_store_dwordx4 v[16:19], v1, s[36:39], s12 offen offset:0 sc1
    v_exp_f32 v94, v94
    v_exp_f32 v95, v95
    v_cvt_pk_bf16_f32 v102, v92, v93
    v_cvt_pk_bf16_f32 v103, v94, v95
    v_exp_f32 v64, v64
    v_exp_f32 v65, v65
    s_waitcnt lgkmcnt(0)
    v_mfma_f32_32x32x16_bf16 v[44:59], v[120:123], v[100:103], v[44:59]
    ds_read_b128 v[120:123], v4 offset:44032
    v_exp_f32 v66, v66
    v_exp_f32 v67, v67
    v_exp_f32 v68, v68
    v_cvt_pk_bf16_f32 v96, v64, v65
    v_cvt_pk_bf16_f32 v97, v66, v67
    v_exp_f32 v69, v69
    v_exp_f32 v70, v70
    v_mfma_f32_32x32x16_bf16 v[80:95], v[104:107], v[36:39], 0
    ds_read_b128 v[116:119], v4 offset:47104
    v_exp_f32 v71, v71
    v_exp_f32 v72, v72
    v_exp_f32 v73, v73
    v_mfma_f32_32x32x16_bf16 v[80:95], v[108:111], v[40:43], v[80:95]
    s_cmp_eq_u32 s3, 0
    s_cbranch_scc0 pok_18
    s_waitcnt vmcnt(5)
    v_cmp_ne_u32 vcc, s58, v241
    s_cbranch_vccz pok_18
    s_mov_b32 s74, 2097152
psp_19:
    s_sleep 4
    buffer_load_dword v241, v240, s[36:39], 0 offen sc1
    s_sub_u32 s74, s74, 1
    s_waitcnt vmcnt(0)
    v_cmp_ne_u32 vcc, s58, v241
    s_cmp_eq_u32 s74, 0
    s_cbranch_scc1 pok_18
    s_cbranch_vccnz psp_19
pok_18:
    s_waitcnt vmcnt(5)
    s_barrier
    ds_read_b128 v[104:107], v3 offset:0
    ds_read_b128 v[108:111], v3 offset:1024
    s_add_u32 m0, s18, 65536
    v_cvt_pk_bf16_f32 v98, v68, v69
    v_cvt_pk_bf16_f32 v99, v70, v71
    v_exp_f32 v74, v74
    v_exp_f32 v75, v75
    buffer_load_dwordx4 v[192:195], v1, s[36:39], s19 offen offset:0 sc1
    v_exp_f32 v76, v76
    v_exp_f32 v77, v77
    v_cvt_pk_bf16_f32 v100, v72, v73
    v_cvt_pk_bf16_f32 v101, v74, v75
    v_mfma_f32_32x32x16_bf16 v[44:59], v[112:115], v[96:99], v[44:59]
    buffer_load_dwordx4 v1, s[36:39], s15 offen offset:0 sc1 lds
    buffer_load_dwordx4 v[200:203], v1, s[36:39], s20 offen offset:0 sc1
    buffer_store_dwordx4 v[20:23], v1, s[36:39], s12 offen offset:1024 sc1
    v_exp_f32 v78, v78
    v_exp_f32 v79, v79
    v_cvt_pk_bf16_f32 v102, v76, v77
    v_cvt_pk_bf16_f32 v103, v78, v79
    v_exp_f32 v80, v80
    v_exp_f32 v81, v81
    s_waitcnt lgkmcnt(0)
    v_mfma_f32_32x32x16_bf16 v[44:59], v[120:123], v[100:103], v[44:59]
    ds_read_b128 v[120:123], v4 offset:48128
    v_exp_f32 v82, v82
    v_exp_f32 v83, v83
    v_exp_f32 v84, v84
    buffer_load_dwordx4 v[196:199], v1, s[36:39], s19 offen offset:1024 sc1
    v_cvt_pk_bf16_f32 v96, v80, v81
    v_cvt_pk_bf16_f32 v97, v82, v83
    v_exp_f32 v85, v85
    v_exp_f32 v86, v86
    v_mfma_f32_32x32x16_bf16 v[64:79], v[104:107], v[36:39], 0
    ds_read_b128 v[112:115], v3 offset:2048
    v_exp_f32 v87, v87
    v_exp_f32 v88, v88
    v_exp_f32 v89, v89
    v_mfma_f32_32x32x16_bf16 v[64:79], v[108:111], v[40:43], v[64:79]
    ds_read_b128 v[104:107], v3 offset:4096
    ds_read_b128 v[108:111], v3 offset:5120
    v_cvt_pk_bf16_f32 v98, v84, v85
    v_cvt_pk_bf16_f32 v99, v86, v87
    v_exp_f32 v90, v90
    v_exp_f32 v91, v91
    buffer_load_dwordx4 v[204:207], v1, s[36:39], s21 offen offset:0 sc1
    v_exp_f32 v92, v92
    v_exp_f32 v93, v93
    v_cvt_pk_bf16_f32 v100, v88, v89
    v_cvt_pk_bf16_f32 v101, v90, v91
    v_mfma_f32_32x32x16_bf16 v[44:59], v[116:119], v[96:99], v[44:59]
    buffer_load_dwordx4 v1, s[36:39], s15 offen offset:1024 sc1 lds
    v_exp_f32 v94, v94
    v_exp_f32 v95, v95
    v_cvt_pk_bf16_f32 v102, v92, v93
    v_cvt_pk_bf16_f32 v103, v94, v95
    v_exp_f32 v64, v64
    v_exp_f32 v65, v65
    s_waitcnt lgkmcnt(0)
    v_mfma_f32_32x32x16_bf16 v[44:59], v[120:123], v[100:103], v[44:59]
    ds_read_b128 v[120:123], v3 offset:3072
    v_exp_f32 v66, v66
    v_exp_f32 v67, v67
    v_exp_f32 v68, v68
    buffer_load_dwordx4 v[208:211], v1, s[36:39], s19 offen offset:2048 sc1
    v_cvt_pk_bf16_f32 v96, v64, v65
    v_cvt_pk_bf16_f32 v97, v66, v67
    v_exp_f32 v69, v69
    v_exp_f32 v70, v70
    v_mfma_f32_32x32x16_bf16 v[80:95], v[104:107], v[36:39], 0
    ds_read_b128 v[116:119], v3 offset:6144
    v_exp_f32 v71, v71
    v_exp_f32 v72, v72
    v_exp_f32 v73, v73
    v_mfma_f32_32x32x16_bf16 v[80:95], v[108:111], v[40:43], v[80:95]
    ds_read_b128 v[104:107], v3 offset:8192
    ds_read_b128 v[108:111], v3 offset:9216
    v_cvt_pk_bf16_f32 v98, v68, v69
    v_cvt_pk_bf16_f32 v99, v70, v71
    v_exp_f32 v74, v74
    v_exp_f32 v75, v75
    v_exp_f32 v76, v76
    v_exp_f32 v77, v77
    v_cvt_pk_bf16_f32 v100, v72, v73
    v_cvt_pk_bf16_f32 v101, v74, v75
    v_mfma_f32_32x32x16_bf16 v[44:59], v[112:115], v[96:99], v[44:59]
    buffer_load_dwordx4 v1, s[36:39], s15 offen offset:2048 sc1 lds
    v_exp_f32 v78, v78
    v_exp_f32 v79, v79
    v_cvt_pk_bf16_f32 v102, v76, v77
    v_cvt_pk_bf16_f32 v103, v78, v79
    v_exp_f32 v80, v80
    v_exp_f32 v81, v81
    s_waitcnt lgkmcnt(0)
    v_mfma_f32_32x32x16_bf16 v[44:59], v[120:123], v[100:103], v[44:59]
    ds_read_b128 v[120:123], v3 offset:7168
    v_exp_f32 v82, v82
    v_exp_f32 v83, v83
    v_exp_f32 v84, v84
    buffer_load_dwordx4 v[216:219], v1, s[36:39], s20 offen offset:1024 sc1
    v_cvt_pk_bf16_f32 v96, v80, v81
    v_cvt_pk_bf16_f32 v97, v82, v83
    v_exp_f32 v85, v85
    v_exp_f32 v86, v86
    v_mfma_f32_32x32x16_bf16 v[64:79], v[104:107], v[36:39], 0
    ds_read_b128 v[112:115], v3 offset:10240
    v_exp_f32 v87, v87
    v_exp_f32 v88, v88
    v_exp_f32 v89, v89
    v_mfma_f32_32x32x16_bf16 v[64:79], v[108:111], v[40:43], v[64:79]
    ds_read_b128 v[104:107], v3 offset:12288
    ds_read_b128 v[108:111], v3 offset:13312
    v_cvt_pk_bf16_f32 v98, v84, v85
    v_cvt_pk_bf16_f32 v99, v86, v87
    v_exp_f32 v90, v90
    v_exp_f32 v91, v91
    v_exp_f32 v92, v92
    v_exp_f32 v93, v93
    v_cvt_pk_bf16_f32 v100, v88, v89
    v_cvt_pk_bf16_f32 v101, v90, v91
    v_mfma_f32_32x32x16_bf16 v[44:59], v[116:119], v[96:99], v[44:59]
    buffer_load_dwordx4 v1, s[36:39], s15 offen offset:3072 sc1 lds
    s_add_u32 s15, s15, 16384
    v_exp_f32 v94, v94
    v_exp_f32 v95, v95
    v_cvt_pk_bf16_f32 v102, v92, v93
    v_cvt_pk_bf16_f32 v103, v94, v95
    v_exp_f32 v64, v64
    v_exp_f32 v65, v65
    s_waitcnt lgkmcnt(0)
    v_mfma_f32_32x32x16_bf16 v[44:59], v[120:123], v[100:103], v[44:59]
    ds_read_b128 v[120:123], v3 offset:11264
    v_exp_f32 v66, v66
    v_exp_f32 v67, v67
    v_exp_f32 v68, v68
    buffer_load_dwordx4 v[212:215], v1, s[36:39], s19 offen offset:3072 sc1
    s_add_u32 s19, s19, 4096
    v_cvt_pk_bf16_f32 v96, v64, v65
    v_cvt_pk_bf16_f32 v97, v66, v67
    v_exp_f32 v69, v69
    v_exp_f32 v70, v70
    v_mfma_f32_32x32x16_bf16 v[80:95], v[104:107], v[36:39], 0
    ds_read_b128 v[116:119], v3 offset:14336
    v_exp_f32 v71, v71
    v_exp_f32 v72, v72
    v_exp_f32 v73, v73
    v_mfma_f32_32x32x16_bf16 v[80:95], v[108:111], v[40:43], v[80:95]
    s_waitcnt vmcnt(8)
    s_barrier
    s_cmp_eq_u32 s3, 0
    s_cbranch_scc0 fl_20
    s_lshl_b32 s6, s4, 5
    s_add_u32 s6, s6, s5
    s_lshl_b32 s6, s6, 2
    s_add_u32 s6, s6, 13862912
    v_mov_b32 v242, s6
    v_mov_b32 v243, s58
    s_mov_b64 exec, 1
    buffer_store_dword v243, v242, s[36:39], 0 offen sc1
    s_mov_b64 exec, -1
fl_20:
    ds_read_b128 v[104:107], v3 offset:32768
    ds_read_b128 v[108:111], v3 offset:33792
    s_add_u32 m0, s18, 98304
    v_cvt_pk_bf16_f32 v98, v68, v69
    v_cvt_pk_bf16_f32 v99, v70, v71
    v_exp_f32 v74, v74
    v_exp_f32 v75, v75
    v_exp_f32 v76, v76
    v_exp_f32 v77, v77
    v_cvt_pk_bf16_f32 v100, v72, v73
    v_cvt_pk_bf16_f32 v101, v74, v75
    v_mfma_f32_32x32x16_bf16 v[44:59], v[112:115], v[96:99], v[44:59]
    buffer_load_dwordx4 v1, s[36:39], s15 offen offset:0 sc1 lds
    v_exp_f32 v78, v78
    v_exp_f32 v79, v79
    v_cvt_pk_bf16_f32 v102, v76, v77
    v_cvt_pk_bf16_f32 v103, v78, v79
    v_exp_f32 v80, v80
    v_exp_f32 v81, v81
    s_waitcnt lgkmcnt(0)
    v_mfma_f32_32x32x16_bf16 v[44:59], v[120:123], v[100:103], v[44:59]
    ds_read_b128 v[120:123], v3 offset:15360
    v_exp_f32 v82, v82
    v_exp_f32 v83, v83
    v_exp_f32 v84, v84
    buffer_load_dwordx4 v[220:223], v1, s[36:39], s21 offen offset:1024 sc1
    v_cvt_pk_bf16_f32 v96, v80, v81
    v_cvt_pk_bf16_f32 v97, v82, v83
    v_exp_f32 v85, v85
    v_exp_f32 v86, v86
    v_mfma_f32_32x32x16_bf16 v[64:79], v[104:107], v[36:39], 0
    ds_read_b128 v[112:115], v3 offset:34816
    v_exp_f32 v87, v87
    v_exp_f32 v88, v88
    v_exp_f32 v89, v89
    v_mfma_f32_32x32x16_bf16 v[64:79], v[108:111], v[40:43], v[64:79]
    ds_read_b128 v[104:107], v3 offset:36864
    ds_read_b128 v[108:111], v3 offset:37888
    v_cvt_pk_bf16_f32 v98, v84, v85
    v_cvt_pk_bf16_f32 v99, v86, v87
    v_exp_f32 v90, v90
    v_exp_f32 v91, v91
    v_exp_f32 v92, v92
    v_exp_f32 v93, v93
    v_cvt_pk_bf16_f32 v100, v88, v89
    v_cvt_pk_bf16_f32 v101, v90, v91
    v_mfma_f32_32x32x16_bf16 v[44:59], v[116:119], v[96:99], v[44:59]
    buffer_load_dwordx4 v1, s[36:39], s15 offen offset:1024 sc1 lds
    v_exp_f32 v94, v94
    v_exp_f32 v95, v95
    v_cvt_pk_bf16_f32 v102, v92, v93
    v_cvt_pk_bf16_f32 v103, v94, v95
    v_exp_f32 v64, v64
    v_exp_f32 v65, v65
    s_waitcnt vmcnt(9) lgkmcnt(0)
    v_mfma_f32_32x32x16_bf16 v[44:59], v[120:123], v[100:103], v[44:59]
    ds_read_b128 v[120:123], v3 offset:35840
    v_exp_f32 v66, v66
    v_exp_f32 v67, v67
    v_exp_f32 v68, v68
    v_mfma_f32_32x32x16_bf16 v[128:143], v[192:195], v[200:203], 0
    buffer_load_dwordx4 v[224:227], v1, s[36:39], s19 offen offset:0 sc1
    v_cvt_pk_bf16_f32 v96, v64, v65
    v_cvt_pk_bf16_f32 v97, v66, v67
    v_exp_f32 v69, v69
    v_exp_f32 v70, v70
    v_mfma_f32_32x32x16_bf16 v[80:95], v[104:107], v[36:39], 0
    ds_read_b128 v[116:119], v3 offset:38912
    v_exp_f32 v71, v71
    v_exp_f32 v72, v72
    v_exp_f32 v73, v73
    v_mfma_f32_32x32x16_bf16 v[80:95], v[108:111], v[40:43], v[80:95]
    ds_read_b128 v[104:107], v3 offset:40960
    ds_read_b128 v[108:111], v3 offset:41984
    v_cvt_pk_bf16_f32 v98, v68, v69
    v_cvt_pk_bf16_f32 v99, v70, v71
    v_exp_f32 v74, v74
    v_exp_f32 v75, v75
    v_mfma_f32_32x32x16_bf16 v[144:159], v[196:199], v[200:203], 0
    buffer_load_dwordx4 v[232:235], v1, s[36:39], s20 offen offset:2048 sc1
    v_exp_f32 v76, v76
    v_exp_f32 v77, v77
    v_cvt_pk_bf16_f32 v100, v72, v73
    v_cvt_pk_bf16_f32 v101, v74, v75
    v_mfma_f32_32x32x16_bf16 v[44:59], v[112:115], v[96:99], v[44:59]
    buffer_load_dwordx4 v1, s[36:39], s15 offen offset:2048 sc1 lds
    v_exp_f32 v78, v78
    v_exp_f32 v79, v79
    v_cvt_pk_bf16_f32 v102, v76, v77
    v_cvt_pk_bf16_f32 v103, v78, v79
    v_exp_f32 v80, v80
    v_exp_f32 v81, v81
    s_waitcnt lgkmcnt(0)
    v_mfma_f32_32x32x16_bf16 v[44:59], v[120:123], v[100:103], v[44:59]
    ds_read_b128 v[120:123], v3 offset:39936
    v_exp_f32 v82, v82
    v_exp_f32 v83, v83
    v_exp_f32 v84, v84
    v_mfma_f32_32x32x16_bf16 v[176:191], v[196:199], v[204:207], 0
    buffer_load_dwordx4 v[228:231], v1, s[36:39], s19 offen offset:1024 sc1
    v_cvt_pk_bf16_f32 v96, v80, v81
    v_cvt_pk_bf16_f32 v97, v82, v83
    v_exp_f32 v85, v85
    v_exp_f32 v86, v86
    v_mfma_f32_32x32x16_bf16 v[64:79], v[104:107], v[36:39], 0
    ds_read_b128 v[112:115], v3 offset:43008
    v_exp_f32 v87, v87
    v_exp_f32 v88, v88
    v_exp_f32 v89, v89
    v_mfma_f32_32x32x16_bf16 v[64:79], v[108:111], v[40:43], v[64:79]
    ds_read_b128 v[104:107], v3 offset:45056
    ds_read_b128 v[108:111], v3 offset:46080
    v_cvt_pk_bf16_f32 v98, v84, v85
    v_cvt_pk_bf16_f32 v99, v86, v87
    v_exp_f32 v90, v90
    v_exp_f32 v91, v91
    v_mfma_f32_32x32x16_bf16 v[160:175], v[192:195], v[204:207], 0
    buffer_load_dwordx4 v[236:239], v1, s[36:39], s21 offen offset:2048 sc1
    v_exp_f32 v92, v92
    v_exp_f32 v93, v93
    v_cvt_pk_bf16_f32 v100, v88, v89
    v_cvt_pk_bf16_f32 v101, v90, v91
    v_mfma_f32_32x32x16_bf16 v[44:59], v[116:119], v[96:99], v[44:59]
    buffer_load_dwordx4 v1, s[36:39], s15 offen offset:3072 sc1 lds
    s_add_u32 s15, s15, 16384
    v_exp_f32 v94, v94
    v_exp_f32 v95, v95
    v_cvt_pk_bf16_f32 v102, v92, v93
    v_cvt_pk_bf16_f32 v103, v94, v95
    v_exp_f32 v64, v64
    v_exp_f32 v65, v65
    s_waitcnt vmcnt(7) lgkmcnt(0)
    v_mfma_f32_32x32x16_bf16 v[44:59], v[120:123], v[100:103], v[44:59]
    ds_read_b128 v[120:123], v3 offset:44032
    v_exp_f32 v66, v66
    v_exp_f32 v67, v67
    v_exp_f32 v68, v68
    v_mfma_f32_32x32x16_bf16 v[128:143], v[208:211], v[216:219], v[128:143]
    buffer_load_dwordx4 v[192:195], v1, s[36:39], s19 offen offset:2048 sc1
    v_cvt_pk_bf16_f32 v96, v64, v65
    v_cvt_pk_bf16_f32 v97, v66, v67
    v_exp_f32 v69, v69
    v_exp_f32 v70, v70
    v_mfma_f32_32x32x16_bf16 v[80:95], v[104:107], v[36:39], 0
    ds_read_b128 v[116:119], v3 offset:47104
    v_exp_f32 v71, v71
    v_exp_f32 v72, v72
    v_exp_f32 v73, v73
    v_mfma_f32_32x32x16_bf16 v[80:95], v[108:111], v[40:43], v[80:95]
    s_barrier
    ds_read_b128 v[104:107], v4 offset:0
    ds_read_b128 v[108:111], v4 offset:1024
    s_add_u32 m0, s18, 0
    v_cvt_pk_bf16_f32 v98, v68, v69
    v_cvt_pk_bf16_f32 v99, v70, v71
    v_exp_f32 v74, v74
    v_exp_f32 v75, v75
    v_mfma_f32_32x32x16_bf16 v[144:159], v[212:215], v[216:219], v[144:159]
    buffer_load_dwordx4 v[200:203], v1, s[36:39], s20 offen offset:3072 sc1
    v_exp_f32 v76, v76
    v_exp_f32 v77, v77
    v_cvt_pk_bf16_f32 v100, v72, v73
    v_cvt_pk_bf16_f32 v101, v74, v75
    v_mfma_f32_32x32x16_bf16 v[44:59], v[112:115], v[96:99], v[44:59]
    buffer_load_dwordx4 v1, s[36:39], s15 offen offset:0 sc1 lds
    v_exp_f32 v78, v78
    v_exp_f32 v79, v79
    v_cvt_pk_bf16_f32 v102, v76, v77
    v_cvt_pk_bf16_f32 v103, v78, v79
    v_exp_f32 v80, v80
    v_exp_f32 v81, v81
    s_waitcnt lgkmcnt(0)
    v_mfma_f32_32x32x16_bf16 v[44:59], v[120:123], v[100:103], v[44:59]
    ds_read_b128 v[120:123], v3 offset:48128
    v_exp_f32 v82, v82
    v_exp_f32 v83, v83
    v_exp_f32 v84, v84
    v_mfma_f32_32x32x16_bf16 v[176:191], v[212:215], v[220:223], v[176:191]
    buffer_load_dwordx4 v[196:199], v1, s[36:39], s19 offen offset:3072 sc1
    s_add_u32 s19, s19, 4096
    v_cvt_pk_bf16_f32 v96, v80, v81
    v_cvt_pk_bf16_f32 v97, v82, v83
    v_exp_f32 v85, v85
    v_exp_f32 v86, v86
    v_mfma_f32_32x32x16_bf16 v[64:79], v[104:107], v[36:39], 0
    ds_read_b128 v[112:115], v4 offset:2048
    v_exp_f32 v87, v87
    v_exp_f32 v88, v88
    v_exp_f32 v89, v89
    v_mfma_f32_32x32x16_bf16 v[64:79], v[108:111], v[40:43], v[64:79]
    ds_read_b128 v[104:107], v4 offset:4096
    ds_read_b128 v[108:111], v4 offset:5120
    v_cvt_pk_bf16_f32 v98, v84, v85
    v_cvt_pk_bf16_f32 v99, v86, v87
    v_exp_f32 v90, v90
    v_exp_f32 v91, v91
    v_mfma_f32_32x32x16_bf16 v[160:175], v[208:211], v[220:223], v[160:175]
    buffer_load_dwordx4 v[204:207], v1, s[36:39], s21 offen offset:3072 sc1
    s_add_u32 s20, s20, 4096
    s_add_u32 s21, s21, 4096
    v_exp_f32 v92, v92
    v_exp_f32 v93, v93
    v_cvt_pk_bf16_f32 v100, v88, v89
    v_cvt_pk_bf16_f32 v101, v90, v91
    v_mfma_f32_32x32x16_bf16 v[44:59], v[116:119], v[96:99], v[44:59]
    buffer_load_dwordx4 v1, s[36:39], s15 offen offset:1024 sc1 lds
    v_exp_f32 v94, v94
    v_exp_f32 v95, v95
    v_cvt_pk_bf16_f32 v102, v92, v93
    v_cvt_pk_bf16_f32 v103, v94, v95
    v_exp_f32 v64, v64
    v_exp_f32 v65, v65
    s_waitcnt vmcnt(7) lgkmcnt(0)
    v_mfma_f32_32x32x16_bf16 v[44:59], v[120:123], v[100:103], v[44:59]
    ds_read_b128 v[120:123], v4 offset:3072
    v_exp_f32 v66, v66
    v_exp_f32 v67, v67
    v_exp_f32 v68, v68
    v_mfma_f32_32x32x16_bf16 v[128:143], v[224:227], v[232:235], v[128:143]
    buffer_load_dwordx4 v[208:211], v1, s[36:39], s19 offen offset:0 sc1
    v_cvt_pk_bf16_f32 v96, v64, v65
    v_cvt_pk_bf16_f32 v97, v66, v67
    v_exp_f32 v69, v69
    v_exp_f32 v70, v70
    v_mfma_f32_32x32x16_bf16 v[80:95], v[104:107], v[36:39], 0
    ds_read_b128 v[116:119], v4 offset:6144
    v_exp_f32 v71, v71
    v_exp_f32 v72, v72
    v_exp_f32 v73, v73
    v_mfma_f32_32x32x16_bf16 v[80:95], v[108:111], v[40:43], v[80:95]
    ds_read_b128 v[104:107], v4 offset:8192
    ds_read_b128 v[108:111], v4 offset:9216
    v_cvt_pk_bf16_f32 v98, v68, v69
    v_cvt_pk_bf16_f32 v99, v70, v71
    v_exp_f32 v74, v74
    v_exp_f32 v75, v75
    v_mfma_f32_32x32x16_bf16 v[144:159], v[228:231], v[232:235], v[144:159]
    buffer_load_dwordx4 v[216:219], v1, s[36:39], s20 offen offset:0 sc1
    v_exp_f32 v76, v76
    v_exp_f32 v77, v77
    v_cvt_pk_bf16_f32 v100, v72, v73
    v_cvt_pk_bf16_f32 v101, v74, v75
    v_mfma_f32_32x32x16_bf16 v[44:59], v[112:115], v[96:99], v[44:59]
    buffer_load_dwordx4 v1, s[36:39], s15 offen offset:2048 sc1 lds
    s_cmp_eq_u32 s3, 0
    s_cbranch_scc0 pi_21
    s_lshl_b32 s6, s4, 7
    s_add_u32 s6, s6, 13862912
    v_and_b32 v240, 15, v0
    v_lshl_add_u32 v240, v240, 2, s6
    buffer_load_dword v241, v240, s[36:39], 0 offen sc1
pi_21:
    v_exp_f32 v78, v78
    v_exp_f32 v79, v79
    v_cvt_pk_bf16_f32 v102, v76, v77
    v_cvt_pk_bf16_f32 v103, v78, v79
    v_exp_f32 v80, v80
    v_exp_f32 v81, v81
    s_waitcnt lgkmcnt(0)
    v_mfma_f32_32x32x16_bf16 v[44:59], v[120:123], v[100:103], v[44:59]
    ds_read_b128 v[120:123], v4 offset:7168
    v_exp_f32 v82, v82
    v_exp_f32 v83, v83
    v_exp_f32 v84, v84
    v_mfma_f32_32x32x16_bf16 v[176:191], v[228:231], v[236:239], v[176:191]
    buffer_load_dwordx4 v[212:215], v1, s[36:39], s19 offen offset:1024 sc1
    v_cvt_pk_bf16_f32 v96, v80, v81
    v_cvt_pk_bf16_f32 v97, v82, v83
    v_exp_f32 v85, v85
    v_exp_f32 v86, v86
    v_mfma_f32_32x32x16_bf16 v[64:79], v[104:107], v[36:39], 0
    ds_read_b128 v[112:115], v4 offset:10240
    v_exp_f32 v87, v87
    v_exp_f32 v88, v88
    v_exp_f32 v89, v89
    v_mfma_f32_32x32x16_bf16 v[64:79], v[108:111], v[40:43], v[64:79]
    ds_read_b128 v[104:107], v4 offset:12288
    ds_read_b128 v[108:111], v4 offset:13312
    v_cvt_pk_bf16_f32 v98, v84, v85
    v_cvt_pk_bf16_f32 v99, v86, v87
    v_exp_f32 v90, v90
    v_exp_f32 v91, v91
    v_mfma_f32_32x32x16_bf16 v[160:175], v[224:227], v[236:239], v[160:175]
    buffer_load_dwordx4 v[220:223], v1, s[36:39], s21 offen offset:0 sc1
    v_exp_f32 v92, v92
    v_exp_f32 v93, v93
    v_cvt_pk_bf16_f32 v100, v88, v89
    v_cvt_pk_bf16_f32 v101, v90, v91
    v_mfma_f32_32x32x16_bf16 v[44:59], v[116:119], v[96:99], v[44:59]
    buffer_load_dwordx4 v1, s[36:39], s15 offen offset:3072 sc1 lds
    s_add_u32 s15, s15, 16384
    v_exp_f32 v94, v94
    v_exp_f32 v95, v95
    v_cvt_pk_bf16_f32 v102, v92, v93
    v_cvt_pk_bf16_f32 v103, v94, v95
    v_exp_f32 v64, v64
    v_exp_f32 v65, v65
    s_waitcnt vmcnt(7) lgkmcnt(0)
    v_mfma_f32_32x32x16_bf16 v[44:59], v[120:123], v[100:103], v[44:59]
    ds_read_b128 v[120:123], v4 offset:11264
    v_exp_f32 v66, v66
    v_exp_f32 v67, v67
    v_exp_f32 v68, v68
    v_mfma_f32_32x32x16_bf16 v[128:143], v[192:195], v[200:203], v[128:143]
    buffer_load_dwordx4 v[224:227], v1, s[36:39], s19 offen offset:2048 sc1
    v_cvt_pk_bf16_f32 v96, v64, v65
    v_cvt_pk_bf16_f32 v97, v66, v67
    v_exp_f32 v69, v69
    v_exp_f32 v70, v70
    v_mfma_f32_32x32x16_bf16 v[80:95], v[104:107], v[36:39], 0
    ds_read_b128 v[116:119], v4 offset:14336
    v_exp_f32 v71, v71
    v_exp_f32 v72, v72
    v_exp_f32 v73, v73
    v_mfma_f32_32x32x16_bf16 v[80:95], v[108:111], v[40:43], v[80:95]
    s_cmp_eq_u32 s3, 0
    s_cbranch_scc0 pok_22
    s_waitcnt vmcnt(4)
    v_cmp_ne_u32 vcc, s58, v241
    s_cbranch_vccz pok_22
    s_mov_b32 s74, 2097152
psp_23:
    s_sleep 4
    buffer_load_dword v241, v240, s[36:39], 0 offen sc1
    s_sub_u32 s74, s74, 1
    s_waitcnt vmcnt(0)
    v_cmp_ne_u32 vcc, s58, v241
    s_cmp_eq_u32 s74, 0
    s_cbranch_scc1 pok_22
    s_cbranch_vccnz psp_23
pok_22:
    s_barrier
    ds_read_b128 v[104:107], v4 offset:32768
    ds_read_b128 v[108:111], v4 offset:33792
    s_add_u32 m0, s18, 32768
    v_cvt_pk_bf16_f32 v98, v68, v69
    v_cvt_pk_bf16_f32 v99, v70, v71
    v_exp_f32 v74, v74
    v_exp_f32 v75, v75
    v_mfma_f32_32x32x16_bf16 v[144:159], v[196:199], v[200:203], v[144:159]
    buffer_load_dwordx4 v[232:235], v1, s[36:39], s20 offen offset:1024 sc1
    v_exp_f32 v76, v76
    v_exp_f32 v77, v77
    v_cvt_pk_bf16_f32 v100, v72, v73
    v_cvt_pk_bf16_f32 v101, v74, v75
    v_mfma_f32_32x32x16_bf16 v[44:59], v[112:115], v[96:99], v[44:59]
    buffer_load_dwordx4 v1, s[36:39], s15 offen offset:0 sc1 lds
    v_exp_f32 v78, v78
    v_exp_f32 v79, v79
    v_cvt_pk_bf16_f32 v102, v76, v77
    v_cvt_pk_bf16_f32 v103, v78, v79
    v_exp_f32 v80, v80
    v_exp_f32 v81, v81
    s_waitcnt lgkmcnt(0)
    v_mfma_f32_32x32x16_bf16 v[44:59], v[120:123], v[100:103], v[44:59]
    ds_read_b128 v[120:123], v4 offset:15360
    v_exp_f32 v82, v82
    v_exp_f32 v83, v83
    v_exp_f32 v84, v84
    v_mfma_f32_32x32x16_bf16 v[176:191], v[196:199], v[204:207], v[176:191]
    buffer_load_dwordx4 v[228:231], v1, s[36:39], s19 offen offset:3072 sc1
    s_add_u32 s19, s19, s23
    v_cvt_pk_bf16_f32 v96, v80, v81
    v_cvt_pk_bf16_f32 v97, v82, v83
    v_exp_f32 v85, v85
    v_exp_f32 v86, v86
    v_mfma_f32_32x32x16_bf16 v[64:79], v[104:107], v[36:39], 0
    ds_read_b128 v[112:115], v4 offset:34816
    v_exp_f32 v87, v87
    v_exp_f32 v88, v88
    v_exp_f32 v89, v89
    v_mfma_f32_32x32x16_bf16 v[64:79], v[108:111], v[40:43], v[64:79]
    ds_read_b128 v[104:107], v4 offset:36864
    ds_read_b128 v[108:111], v4 offset:37888
    v_cvt_pk_bf16_f32 v98, v84, v85
    v_cvt_pk_bf16_f32 v99, v86, v87
    v_exp_f32 v90, v90
    v_exp_f32 v91, v91
    v_mfma_f32_32x32x16_bf16 v[160:175], v[192:195], v[204:207], v[160:175]
    buffer_load_dwordx4 v[236:239], v1, s[36:39], s21 offen offset:1024 sc1
    s_add_u32 s20, s20, s28
    s_add_u32 s21, s21, s28
    v_exp_f32 v92, v92
    v_exp_f32 v93, v93
    v_cvt_pk_bf16_f32 v100, v88, v89
    v_cvt_pk_bf16_f32 v101, v90, v91
    v_mfma_f32_32x32x16_bf16 v[44:59], v[116:119], v[96:99], v[44:59]
    buffer_load_dwordx4 v1, s[36:39], s15 offen offset:1024 sc1 lds
    v_exp_f32 v94, v94
    v_exp_f32 v95, v95
    v_cvt_pk_bf16_f32 v102, v92, v93
    v_cvt_pk_bf16_f32 v103, v94, v95
    v_exp_f32 v64, v64
    v_exp_f32 v65, v65
    s_waitcnt vmcnt(7) lgkmcnt(0)
    v_mfma_f32_32x32x16_bf16 v[44:59], v[120:123], v[100:103], v[44:59]
    ds_read_b128 v[120:123], v4 offset:35840
    v_exp_f32 v66, v66
    v_exp_f32 v67, v67
    v_exp_f32 v68, v68
    v_mfma_f32_32x32x16_bf16 v[128:143], v[208:211], v[216:219], v[128:143]
    buffer_load_dwordx4 v[192:195], v1, s[36:39], s19 offen offset:0 sc1
    v_cvt_pk_bf16_f32 v96, v64, v65
    v_cvt_pk_bf16_f32 v97, v66, v67
    v_exp_f32 v69, v69
    v_exp_f32 v70, v70
    v_mfma_f32_32x32x16_bf16 v[80:95], v[104:107], v[36:39], 0
    ds_read_b128 v[116:119], v4 offset:38912
    v_exp_f32 v71, v71
    v_exp_f32 v72, v72
    v_exp_f32 v73, v73
    v_mfma_f32_32x32x16_bf16 v[80:95], v[108:111], v[40:43], v[80:95]
    ds_read_b128 v[104:107], v4 offset:40960
    ds_read_b128 v[108:111], v4 offset:41984
    v_cvt_pk_bf16_f32 v98, v68, v69
    v_cvt_pk_bf16_f32 v99, v70, v71
    v_exp_f32 v74, v74
    v_exp_f32 v75, v75
    v_mfma_f32_32x32x16_bf16 v[144:159], v[212:215], v[216:219], v[144:159]
    buffer_load_dwordx4 v[200:203], v1, s[36:39], s20 offen offset:0 sc1
    v_exp_f32 v76, v76
    v_exp_f32 v77, v77
    v_cvt_pk_bf16_f32 v100, v72, v73
    v_cvt_pk_bf16_f32 v101, v74, v75
    v_mfma_f32_32x32x16_bf16 v[44:59], v[112:115], v[96:99], v[44:59]
    buffer_load_dwordx4 v1, s[36:39], s15 offen offset:2048 sc1 lds
    s_cmp_eq_u32 s3, 0
    s_cbranch_scc0 pi_24
    s_and_b32 s6, s5, 7
    s_lshl_b32 s6, s6, 8
    s_add_u32 s6, s6, 13860976
    v_and_b32 v240, 7, v0
    v_lshl_add_u32 v240, v240, 2, s6
    buffer_load_dword v241, v240, s[36:39], 0 offen sc1
pi_24:
    v_exp_f32 v78, v78
    v_exp_f32 v79, v79
    v_cvt_pk_bf16_f32 v102, v76, v77
    v_cvt_pk_bf16_f32 v103, v78, v79
    v_exp_f32 v80, v80
    v_exp_f32 v81, v81
    s_waitcnt lgkmcnt(0)
    v_mfma_f32_32x32x16_bf16 v[44:59], v[120:123], v[100:103], v[44:59]
    ds_read_b128 v[120:123], v4 offset:39936
    v_exp_f32 v82, v82
    v_exp_f32 v83, v83
    v_exp_f32 v84, v84
    v_mfma_f32_32x32x16_bf16 v[176:191], v[212:215], v[220:223], v[176:191]
    buffer_load_dwordx4 v[196:199], v1, s[36:39], s19 offen offset:1024 sc1
    v_cvt_pk_bf16_f32 v96, v80, v81
    v_cvt_pk_bf16_f32 v97, v82, v83
    v_exp_f32 v85, v85
    v_exp_f32 v86, v86
    v_mfma_f32_32x32x16_bf16 v[64:79], v[104:107], v[36:39], 0
    ds_read_b128 v[112:115], v4 offset:43008
    v_exp_f32 v87, v87
    v_exp_f32 v88, v88
    v_exp_f32 v89, v89
    v_mfma_f32_32x32x16_bf16 v[64:79], v[108:111], v[40:43], v[64:79]
    ds_read_b128 v[104:107], v4 offset:45056
    ds_read_b128 v[108:111], v4 offset:46080
    v_cvt_pk_bf16_f32 v98, v84, v85
    v_cvt_pk_bf16_f32 v99, v86, v87
    v_exp_f32 v90, v90
    v_exp_f32 v91, v91
    v_mfma_f32_32x32x16_bf16 v[160:175], v[208:211], v[220:223], v[160:175]
    buffer_load_dwordx4 v[204:207], v1, s[36:39], s21 offen offset:0 sc1
    v_exp_f32 v92, v92
    v_exp_f32 v93, v93
    v_cvt_pk_bf16_f32 v100, v88, v89
    v_cvt_pk_bf16_f32 v101, v90, v91
    v_mfma_f32_32x32x16_bf16 v[44:59], v[116:119], v[96:99], v[44:59]
    buffer_load_dwordx4 v1, s[36:39], s15 offen offset:3072 sc1 lds
    s_add_u32 s15, s15, 16384
    v_exp_f32 v94, v94
    v_exp_f32 v95, v95
    v_cvt_pk_bf16_f32 v102, v92, v93
    v_cvt_pk_bf16_f32 v103, v94, v95
    v_exp_f32 v64, v64
    v_exp_f32 v65, v65
    s_waitcnt vmcnt(7) lgkmcnt(0)
    v_mfma_f32_32x32x16_bf16 v[44:59], v[120:123], v[100:103], v[44:59]
    ds_read_b128 v[120:123], v4 offset:44032
    v_exp_f32 v66, v66
    v_exp_f32 v67, v67
    v_exp_f32 v68, v68
    v_mfma_f32_32x32x16_bf16 v[128:143], v[224:227], v[232:235], v[128:143]
    buffer_load_dwordx4 v[208:211], v1, s[36:39], s19 offen offset:2048 sc1
    v_cvt_pk_bf16_f32 v96, v64, v65
    v_cvt_pk_bf16_f32 v97, v66, v67
    v_exp_f32 v69, v69
    v_exp_f32 v70, v70
    v_mfma_f32_32x32x16_bf16 v[80:95], v[104:107], v[36:39], 0
    ds_read_b128 v[116:119], v4 offset:47104
    v_exp_f32 v71, v71
    v_exp_f32 v72, v72
    v_exp_f32 v73, v73
    v_mfma_f32_32x32x16_bf16 v[80:95], v[108:111], v[40:43], v[80:95]
    s_cmp_eq_u32 s3, 0
    s_cbranch_scc0 pok_25
    s_waitcnt vmcnt(4)
    v_cmp_ne_u32 vcc, s58, v241
    s_cbranch_vccz pok_25
    s_mov_b32 s74, 2097152
psp_26:
    s_sleep 4
    buffer_load_dword v241, v240, s[36:39], 0 offen sc1
    s_sub_u32 s74, s74, 1
    s_waitcnt vmcnt(0)
    v_cmp_ne_u32 vcc, s58, v241
    s_cmp_eq_u32 s74, 0
    s_cbranch_scc1 pok_25
    s_cbranch_vccnz psp_26
pok_25:
    s_barrier
    ds_read_b128 v[104:107], v3 offset:0
    ds_read_b128 v[108:111], v3 offset:1024
    s_add_u32 m0, s18, 65536
    v_cvt_pk_bf16_f32 v98, v68, v69
    v_cvt_pk_bf16_f32 v99, v70, v71
    v_exp_f32 v74, v74
    v_exp_f32 v75, v75
    v_mfma_f32_32x32x16_bf16 v[144:159], v[228:231], v[232:235], v[144:159]
    buffer_load_dwordx4 v[216:219], v1, s[36:39], s20 offen offset:1024 sc1
    v_exp_f32 v76, v76
    v_exp_f32 v77, v77
    v_cvt_pk_bf16_f32 v100, v72, v73
    v_cvt_pk_bf16_f32 v101, v74, v75
    v_mfma_f32_32x32x16_bf16 v[44:59], v[112:115], v[96:99], v[44:59]
    buffer_load_dwordx4 v1, s[36:39], s15 offen offset:0 sc1 lds
    v_exp_f32 v78, v78
    v_exp_f32 v79, v79
    v_cvt_pk_bf16_f32 v102, v76, v77
    v_cvt_pk_bf16_f32 v103, v78, v79
    v_exp_f32 v80, v80
    v_exp_f32 v81, v81
    s_waitcnt lgkmcnt(0)
    v_mfma_f32_32x32x16_bf16 v[44:59], v[120:123], v[100:103], v[44:59]
    ds_read_b128 v[120:123], v4 offset:48128
    v_exp_f32 v82, v82
    v_exp_f32 v83, v83
    v_exp_f32 v84, v84
    v_mfma_f32_32x32x16_bf16 v[176:191], v[228:231], v[236:239], v[176:191]
    buffer_load_dwordx4 v[212:215], v1, s[36:39], s19 offen offset:3072 sc1
    s_add_u32 s19, s19, 4096
    v_cvt_pk_bf16_f32 v96, v80, v81
    v_cvt_pk_bf16_f32 v97, v82, v83
    v_exp_f32 v85, v85
    v_exp_f32 v86, v86
    v_mfma_f32_32x32x16_bf16 v[64:79], v[104:107], v[36:39], 0
    ds_read_b128 v[112:115], v3 offset:2048
    v_exp_f32 v87, v87
    v_exp_f32 v88, v88
    v_exp_f32 v89, v89
    v_mfma_f32_32x32x16_bf16 v[64:79], v[108:111], v[40:43], v[64:79]
    ds_read_b128 v[104:107], v3 offset:4096
    ds_read_b128 v[108:111], v3 offset:5120
    v_cvt_pk_bf16_f32 v98, v84, v85
    v_cvt_pk_bf16_f32 v99, v86, v87
    v_exp_f32 v90, v90
    v_exp_f32 v91, v91
    v_mfma_f32_32x32x16_bf16 v[160:175], v[224:227], v[236:239], v[160:175]
    buffer_load_dwordx4 v[220:223], v1, s[36:39], s21 offen offset:1024 sc1
    v_exp_f32 v92, v92
    v_exp_f32 v93, v93
    v_cvt_pk_bf16_f32 v100, v88, v89
    v_cvt_pk_bf16_f32 v101, v90, v91
    v_mfma_f32_32x32x16_bf16 v[44:59], v[116:119], v[96:99], v[44:59]
    buffer_load_dwordx4 v1, s[36:39], s15 offen offset:1024 sc1 lds
    v_exp_f32 v94, v94
    v_exp_f32 v95, v95
    v_cvt_pk_bf16_f32 v102, v92, v93
    v_cvt_pk_bf16_f32 v103, v94, v95
    v_exp_f32 v64, v64
    v_exp_f32 v65, v65
    s_waitcnt vmcnt(7) lgkmcnt(0)
    v_mfma_f32_32x32x16_bf16 v[44:59], v[120:123], v[100:103], v[44:59]
    ds_read_b128 v[120:123], v3 offset:3072
    v_exp_f32 v66, v66
    v_exp_f32 v67, v67
    v_exp_f32 v68, v68
    v_mfma_f32_32x32x16_bf16 v[128:143], v[192:195], v[200:203], v[128:143]
    buffer_load_dwordx4 v[224:227], v1, s[36:39], s19 offen offset:0 sc1
    v_cvt_pk_bf16_f32 v96, v64, v65
    v_cvt_pk_bf16_f32 v97, v66, v67
    v_exp_f32 v69, v69
    v_exp_f32 v70, v70
    v_mfma_f32_32x32x16_bf16 v[80:95], v[104:107], v[36:39], 0
    ds_read_b128 v[116:119], v3 offset:6144
    v_exp_f32 v71, v71
    v_exp_f32 v72, v72
    v_exp_f32 v73, v73
    v_mfma_f32_32x32x16_bf16 v[80:95], v[108:111], v[40:43], v[80:95]
    ds_read_b128 v[104:107], v3 offset:8192
    ds_read_b128 v[108:111], v3 offset:9216
    v_cvt_pk_bf16_f32 v98, v68, v69
    v_cvt_pk_bf16_f32 v99, v70, v71
    v_exp_f32 v74, v74
    v_exp_f32 v75, v75
    v_mfma_f32_32x32x16_bf16 v[144:159], v[196:199], v[200:203], v[144:159]
    buffer_load_dwordx4 v[232:235], v1, s[36:39], s20 offen offset:2048 sc1
    v_exp_f32 v76, v76
    v_exp_f32 v77, v77
    v_cvt_pk_bf16_f32 v100, v72, v73
    v_cvt_pk_bf16_f32 v101, v74, v75
    v_mfma_f32_32x32x16_bf16 v[44:59], v[112:115], v[96:99], v[44:59]
    buffer_load_dwordx4 v1, s[36:39], s15 offen offset:2048 sc1 lds
    v_exp_f32 v78, v78
    v_exp_f32 v79, v79
    v_cvt_pk_bf16_f32 v102, v76, v77
    v_cvt_pk_bf16_f32 v103, v78, v79
    v_exp_f32 v80, v80
    v_exp_f32 v81, v81
    s_waitcnt lgkmcnt(0)
    v_mfma_f32_32x32x16_bf16 v[44:59], v[120:123], v[100:103], v[44:59]
    ds_read_b128 v[120:123], v3 offset:7168
    v_exp_f32 v82, v82
    v_exp_f32 v83, v83
    v_exp_f32 v84, v84
    v_mfma_f32_32x32x16_bf16 v[176:191], v[196:199], v[204:207], v[176:191]
    buffer_load_dwordx4 v[228:231], v1, s[36:39], s19 offen offset:1024 sc1
    v_cvt_pk_bf16_f32 v96, v80, v81
    v_cvt_pk_bf16_f32 v97, v82, v83
    v_exp_f32 v85, v85
    v_exp_f32 v86, v86
    v_mfma_f32_32x32x16_bf16 v[64:79], v[104:107], v[36:39], 0
    ds_read_b128 v[112:115], v3 offset:10240
    v_exp_f32 v87, v87
    v_exp_f32 v88, v88
    v_exp_f32 v89, v89
    v_mfma_f32_32x32x16_bf16 v[64:79], v[108:111], v[40:43], v[64:79]
    ds_read_b128 v[104:107], v3 offset:12288
    ds_read_b128 v[108:111], v3 offset:13312
    v_cvt_pk_bf16_f32 v98, v84, v85
    v_cvt_pk_bf16_f32 v99, v86, v87
    v_exp_f32 v90, v90
    v_exp_f32 v91, v91
    v_mfma_f32_32x32x16_bf16 v[160:175], v[192:195], v[204:207], v[160:175]
    buffer_load_dwordx4 v[236:239], v1, s[36:39], s21 offen offset:2048 sc1
    v_exp_f32 v92, v92
    v_exp_f32 v93, v93
    v_cvt_pk_bf16_f32 v100, v88, v89
    v_cvt_pk_bf16_f32 v101, v90, v91
    v_mfma_f32_32x32x16_bf16 v[44:59], v[116:119], v[96:99], v[44:59]
    buffer_load_dwordx4 v1, s[36:39], s15 offen offset:3072 sc1 lds
    s_add_u32 s15, s15, 16384
    v_exp_f32 v94, v94
    v_exp_f32 v95, v95
    v_cvt_pk_bf16_f32 v102, v92, v93
    v_cvt_pk_bf16_f32 v103, v94, v95
    v_exp_f32 v64, v64
    v_exp_f32 v65, v65
    s_waitcnt vmcnt(7) lgkmcnt(0)
    v_mfma_f32_32x32x16_bf16 v[44:59], v[120:123], v[100:103], v[44:59]
    ds_read_b128 v[120:123], v3 offset:11264
    v_exp_f32 v66, v66
    v_exp_f32 v67, v67
    v_exp_f32 v68, v68
    v_mfma_f32_32x32x16_bf16 v[128:143], v[208:211], v[216:219], v[128:143]
    buffer_load_dwordx4 v[192:195], v1, s[36:39], s19 offen offset:2048 sc1
    v_cvt_pk_bf16_f32 v96, v64, v65
    v_cvt_pk_bf16_f32 v97, v66, v67
    v_exp_f32 v69, v69
    v_exp_f32 v70, v70
    v_mfma_f32_32x32x16_bf16 v[80:95], v[104:107], v[36:39], 0
    ds_read_b128 v[116:119], v3 offset:14336
    v_exp_f32 v71, v71
    v_exp_f32 v72, v72
    v_exp_f32 v73, v73
    v_mfma_f32_32x32x16_bf16 v[80:95], v[108:111], v[40:43], v[80:95]
    s_barrier
    ds_read_b128 v[104:107], v3 offset:32768
    ds_read_b128 v[108:111], v3 offset:33792
    v_cvt_pk_bf16_f32 v98, v68, v69
    v_cvt_pk_bf16_f32 v99, v70, v71
    v_exp_f32 v74, v74
    v_exp_f32 v75, v75
    v_mfma_f32_32x32x16_bf16 v[144:159], v[212:215], v[216:219], v[144:159]
    buffer_load_dwordx4 v[200:203], v1, s[36:39], s20 offen offset:3072 sc1
    v_exp_f32 v76, v76
    v_exp_f32 v77, v77
    v_cvt_pk_bf16_f32 v100, v72, v73
    v_cvt_pk_bf16_f32 v101, v74, v75
    v_mfma_f32_32x32x16_bf16 v[44:59], v[112:115], v[96:99], v[44:59]
    s_add_u32 m0, s44, 98304
    s_nop 0
    buffer_load_dwordx4 v1, s[36:39], s29 offen offset:0 sc1 lds
    v_exp_f32 v78, v78
    v_exp_f32 v79, v79
    v_cvt_pk_bf16_f32 v102, v76, v77
    v_cvt_pk_bf16_f32 v103, v78, v79
    v_exp_f32 v80, v80
    v_exp_f32 v81, v81
    s_waitcnt lgkmcnt(0)
    v_mfma_f32_32x32x16_bf16 v[44:59], v[120:123], v[100:103], v[44:59]
    ds_read_b128 v[120:123], v3 offset:15360
    v_exp_f32 v82, v82
    v_exp_f32 v83, v83
    v_exp_f32 v84, v84
    v_mfma_f32_32x32x16_bf16 v[176:191], v[212:215], v[220:223], v[176:191]
    buffer_load_dwordx4 v[196:199], v1, s[36:39], s19 offen offset:3072 sc1
    s_add_u32 s19, s19, 4096
    v_cvt_pk_bf16_f32 v96, v80, v81
    v_cvt_pk_bf16_f32 v97, v82, v83
    v_exp_f32 v85, v85
    v_exp_f32 v86, v86
    v_mfma_f32_32x32x16_bf16 v[64:79], v[104:107], v[36:39], 0
    ds_read_b128 v[112:115], v3 offset:34816
    v_exp_f32 v87, v87
    v_exp_f32 v88, v88
    v_exp_f32 v89, v89
    v_mfma_f32_32x32x16_bf16 v[64:79], v[108:111], v[40:43], v[64:79]
    ds_read_b128 v[104:107], v3 offset:36864
    ds_read_b128 v[108:111], v3 offset:37888
    v_cvt_pk_bf16_f32 v98, v84, v85
    v_cvt_pk_bf16_f32 v99, v86, v87
    v_exp_f32 v90, v90
    v_exp_f32 v91, v91
    v_mfma_f32_32x32x16_bf16 v[160:175], v[208:211], v[220:223], v[160:175]
    buffer_load_dwordx4 v[204:207], v1, s[36:39], s21 offen offset:3072 sc1
    s_add_u32 s20, s20, 4096
    s_add_u32 s21, s21, 4096
    v_exp_f32 v92, v92
    v_exp_f32 v93, v93
    v_cvt_pk_bf16_f32 v100, v88, v89
    v_cvt_pk_bf16_f32 v101, v90, v91
    v_mfma_f32_32x32x16_bf16 v[44:59], v[116:119], v[96:99], v[44:59]
    buffer_load_dwordx4 v1, s[36:39], s29 offen offset:1024 sc1 lds
    v_exp_f32 v94, v94
    v_exp_f32 v95, v95
    v_cvt_pk_bf16_f32 v102, v92, v93
    v_cvt_pk_bf16_f32 v103, v94, v95
    v_exp_f32 v64, v64
    v_exp_f32 v65, v65
    s_waitcnt vmcnt(7) lgkmcnt(0)
    v_mfma_f32_32x32x16_bf16 v[44:59], v[120:123], v[100:103], v[44:59]
    ds_read_b128 v[120:123], v3 offset:35840
    v_exp_f32 v66, v66
    v_exp_f32 v67, v67
    v_exp_f32 v68, v68
    v_mfma_f32_32x32x16_bf16 v[128:143], v[224:227], v[232:235], v[128:143]
    buffer_load_dwordx4 v[208:211], v1, s[36:39], s19 offen offset:0 sc1
    v_cvt_pk_bf16_f32 v96, v64, v65
    v_cvt_pk_bf16_f32 v97, v66, v67
    v_exp_f32 v69, v69
    v_exp_f32 v70, v70
    v_mfma_f32_32x32x16_bf16 v[80:95], v[104:107], v[36:39], 0
    ds_read_b128 v[116:119], v3 offset:38912
    v_exp_f32 v71, v71
    v_exp_f32 v72, v72
    v_exp_f32 v73, v73
    v_mfma_f32_32x32x16_bf16 v[80:95], v[108:111], v[40:43], v[80:95]
    ds_read_b128 v[104:107], v3 offset:40960
    ds_read_b128 v[108:111], v3 offset:41984
    v_cvt_pk_bf16_f32 v98, v68, v69
    v_cvt_pk_bf16_f32 v99, v70, v71
    v_exp_f32 v74, v74
    v_exp_f32 v75, v75
    v_mfma_f32_32x32x16_bf16 v[144:159], v[228:231], v[232:235], v[144:159]
    buffer_load_dwordx4 v[216:219], v1, s[36:39], s20 offen offset:0 sc1
    v_exp_f32 v76, v76
    v_exp_f32 v77, v77
    v_cvt_pk_bf16_f32 v100, v72, v73
    v_cvt_pk_bf16_f32 v101, v74, v75
    v_mfma_f32_32x32x16_bf16 v[44:59], v[112:115], v[96:99], v[44:59]
    buffer_load_dwordx4 v1, s[36:39], s29 offen offset:2048 sc1 lds
    v_exp_f32 v78, v78
    v_exp_f32 v79, v79
    v_cvt_pk_bf16_f32 v102, v76, v77
    v_cvt_pk_bf16_f32 v103, v78, v79
    v_exp_f32 v80, v80
    v_exp_f32 v81, v81
    s_waitcnt lgkmcnt(0)
    v_mfma_f32_32x32x16_bf16 v[44:59], v[120:123], v[100:103], v[44:59]
    ds_read_b128 v[120:123], v3 offset:39936
    v_exp_f32 v82, v82
    v_exp_f32 v83, v83
    v_exp_f32 v84, v84
    v_mfma_f32_32x32x16_bf16 v[176:191], v[228:231], v[236:239], v[176:191]
    buffer_load_dwordx4 v[212:215], v1, s[36:39], s19 offen offset:1024 sc1
    v_cvt_pk_bf16_f32 v96, v80, v81
    v_cvt_pk_bf16_f32 v97, v82, v83
    v_exp_f32 v85, v85
    v_exp_f32 v86, v86
    v_mfma_f32_32x32x16_bf16 v[64:79], v[104:107], v[36:39], 0
    ds_read_b128 v[112:115], v3 offset:43008
    v_exp_f32 v87, v87
    v_exp_f32 v88, v88
    v_exp_f32 v89, v89
    v_mfma_f32_32x32x16_bf16 v[64:79], v[108:111], v[40:43], v[64:79]
    ds_read_b128 v[104:107], v3 offset:45056
    ds_read_b128 v[108:111], v3 offset:46080
    v_cvt_pk_bf16_f32 v98, v84, v85
    v_cvt_pk_bf16_f32 v99, v86, v87
    v_exp_f32 v90, v90
    v_exp_f32 v91, v91
    v_mfma_f32_32x32x16_bf16 v[160:175], v[224:227], v[236:239], v[160:175]
    buffer_load_dwordx4 v[220:223], v1, s[36:39], s21 offen offset:0 sc1
    v_exp_f32 v92, v92
    v_exp_f32 v93, v93
    v_cvt_pk_bf16_f32 v100, v88, v89
    v_cvt_pk_bf16_f32 v101, v90, v91
    v_mfma_f32_32x32x16_bf16 v[44:59], v[116:119], v[96:99], v[44:59]
    buffer_load_dwordx4 v1, s[36:39], s29 offen offset:3072 sc1 lds
    v_exp_f32 v94, v94
    v_exp_f32 v95, v95
    v_cvt_pk_bf16_f32 v102, v92, v93
    v_cvt_pk_bf16_f32 v103, v94, v95
    v_exp_f32 v64, v64
    v_exp_f32 v65, v65
    s_waitcnt vmcnt(7) lgkmcnt(0)
    v_mfma_f32_32x32x16_bf16 v[44:59], v[120:123], v[100:103], v[44:59]
    ds_read_b128 v[120:123], v3 offset:44032
    v_exp_f32 v66, v66
    v_exp_f32 v67, v67
    v_exp_f32 v68, v68
    v_mfma_f32_32x32x16_bf16 v[128:143], v[192:195], v[200:203], v[128:143]
    buffer_load_dwordx4 v[224:227], v1, s[36:39], s19 offen offset:2048 sc1
    v_cvt_pk_bf16_f32 v96, v64, v65
    v_cvt_pk_bf16_f32 v97, v66, v67
    v_exp_f32 v69, v69
    v_exp_f32 v70, v70
    v_mfma_f32_32x32x16_bf16 v[80:95], v[104:107], v[36:39], 0
    ds_read_b128 v[116:119], v3 offset:47104
    v_exp_f32 v71, v71
    v_exp_f32 v72, v72
    v_exp_f32 v73, v73
    v_mfma_f32_32x32x16_bf16 v[80:95], v[108:111], v[40:43], v[80:95]
    s_barrier
    ds_read_b128 v[104:107], v4 offset:0
    ds_read_b128 v[108:111], v4 offset:1024
    v_cvt_pk_bf16_f32 v98, v68, v69
    v_cvt_pk_bf16_f32 v99, v70, v71
    v_exp_f32 v74, v74
    v_exp_f32 v75, v75
    v_mfma_f32_32x32x16_bf16 v[144:159], v[196:199], v[200:203], v[144:159]
    buffer_load_dwordx4 v[232:235], v1, s[36:39], s20 offen offset:1024 sc1
    v_exp_f32 v76, v76
    v_exp_f32 v77, v77
    v_cvt_pk_bf16_f32 v100, v72, v73
    v_cvt_pk_bf16_f32 v101, v74, v75
    v_mfma_f32_32x32x16_bf16 v[44:59], v[112:115], v[96:99], v[44:59]
    s_mov_b32 m0, s44
    s_add_u32 s29, s29, 8192
    buffer_load_dwordx4 v1, s[36:39], s29 offen offset:0 sc1 lds
    v_exp_f32 v78, v78
    v_exp_f32 v79, v79
    v_cvt_pk_bf16_f32 v102, v76, v77
    v_cvt_pk_bf16_f32 v103, v78, v79
    v_exp_f32 v80, v80
    v_exp_f32 v81, v81
    s_waitcnt lgkmcnt(0)
    v_mfma_f32_32x32x16_bf16 v[44:59], v[120:123], v[100:103], v[44:59]
    ds_read_b128 v[120:123], v3 offset:48128
    v_exp_f32 v82, v82
    v_exp_f32 v83, v83
    v_exp_f32 v84, v84
    v_mfma_f32_32x32x16_bf16 v[176:191], v[196:199], v[204:207], v[176:191]
    buffer_load_dwordx4 v[228:231], v1, s[36:39], s19 offen offset:3072 sc1
    s_add_u32 s19, s19, 4096
    v_cvt_pk_bf16_f32 v96, v80, v81
    v_cvt_pk_bf16_f32 v97, v82, v83
    v_exp_f32 v85, v85
    v_exp_f32 v86, v86
    v_mfma_f32_32x32x16_bf16 v[64:79], v[104:107], v[36:39], 0
    ds_read_b128 v[112:115], v4 offset:2048
    v_exp_f32 v87, v87
    v_exp_f32 v88, v88
    v_exp_f32 v89, v89
    v_mfma_f32_32x32x16_bf16 v[64:79], v[108:111], v[40:43], v[64:79]
    ds_read_b128 v[104:107], v4 offset:4096
    ds_read_b128 v[108:111], v4 offset:5120
    v_cvt_pk_bf16_f32 v98, v84, v85
    v_cvt_pk_bf16_f32 v99, v86, v87
    v_exp_f32 v90, v90
    v_exp_f32 v91, v91
    v_mfma_f32_32x32x16_bf16 v[160:175], v[192:195], v[204:207], v[160:175]
    buffer_load_dwordx4 v[236:239], v1, s[36:39], s21 offen offset:1024 sc1
    v_exp_f32 v92, v92
    v_exp_f32 v93, v93
    v_cvt_pk_bf16_f32 v100, v88, v89
    v_cvt_pk_bf16_f32 v101, v90, v91
    v_mfma_f32_32x32x16_bf16 v[44:59], v[116:119], v[96:99], v[44:59]
    buffer_load_dwordx4 v1, s[36:39], s29 offen offset:1024 sc1 lds
    v_exp_f32 v94, v94
    v_exp_f32 v95, v95
    v_cvt_pk_bf16_f32 v102, v92, v93
    v_cvt_pk_bf16_f32 v103, v94, v95
    v_exp_f32 v64, v64
    v_exp_f32 v65, v65
    s_waitcnt vmcnt(7) lgkmcnt(0)
    v_mfma_f32_32x32x16_bf16 v[44:59], v[120:123], v[100:103], v[44:59]
    ds_read_b128 v[120:123], v4 offset:3072
    v_exp_f32 v66, v66
    v_exp_f32 v67, v67
    v_exp_f32 v68, v68
    v_mfma_f32_32x32x16_bf16 v[128:143], v[208:211], v[216:219], v[128:143]
    buffer_load_dwordx4 v[192:195], v1, s[36:39], s19 offen offset:0 sc1
    v_cvt_pk_bf16_f32 v96, v64, v65
    v_cvt_pk_bf16_f32 v97, v66, v67
    v_exp_f32 v69, v69
    v_exp_f32 v70, v70
    v_mfma_f32_32x32x16_bf16 v[80:95], v[104:107], v[36:39], 0
    ds_read_b128 v[116:119], v4 offset:6144
    v_exp_f32 v71, v71
    v_exp_f32 v72, v72
    v_exp_f32 v73, v73
    v_mfma_f32_32x32x16_bf16 v[80:95], v[108:111], v[40:43], v[80:95]
    ds_read_b128 v[104:107], v4 offset:8192
    ds_read_b128 v[108:111], v4 offset:9216
    v_cvt_pk_bf16_f32 v98, v68, v69
    v_cvt_pk_bf16_f32 v99, v70, v71
    v_exp_f32 v74, v74
    v_exp_f32 v75, v75
    v_mfma_f32_32x32x16_bf16 v[144:159], v[212:215], v[216:219], v[144:159]
    buffer_load_dwordx4 v[200:203], v1, s[36:39], s20 offen offset:2048 sc1
    v_exp_f32 v76, v76
    v_exp_f32 v77, v77
    v_cvt_pk_bf16_f32 v100, v72, v73
    v_cvt_pk_bf16_f32 v101, v74, v75
    v_mfma_f32_32x32x16_bf16 v[44:59], v[112:115], v[96:99], v[44:59]
    buffer_load_dwordx4 v1, s[36:39], s29 offen offset:2048 sc1 lds
    v_exp_f32 v78, v78
    v_exp_f32 v79, v79
    v_cvt_pk_bf16_f32 v102, v76, v77
    v_cvt_pk_bf16_f32 v103, v78, v79
    v_exp_f32 v80, v80
    v_exp_f32 v81, v81
    s_waitcnt lgkmcnt(0)
    v_mfma_f32_32x32x16_bf16 v[44:59], v[120:123], v[100:103], v[44:59]
    ds_read_b128 v[120:123], v4 offset:7168
    v_exp_f32 v82, v82
    v_exp_f32 v83, v83
    v_exp_f32 v84, v84
    v_mfma_f32_32x32x16_bf16 v[176:191], v[212:215], v[220:223], v[176:191]
    buffer_load_dwordx4 v[196:199], v1, s[36:39], s19 offen offset:1024 sc1
    v_cvt_pk_bf16_f32 v96, v80, v81
    v_cvt_pk_bf16_f32 v97, v82, v83
    v_exp_f32 v85, v85
    v_exp_f32 v86, v86
    v_mfma_f32_32x32x16_bf16 v[64:79], v[104:107], v[36:39], 0
    ds_read_b128 v[112:115], v4 offset:10240
    v_exp_f32 v87, v87
    v_exp_f32 v88, v88
    v_exp_f32 v89, v89
    v_mfma_f32_32x32x16_bf16 v[64:79], v[108:111], v[40:43], v[64:79]
    ds_read_b128 v[104:107], v4 offset:12288
    ds_read_b128 v[108:111], v4 offset:13312
    v_cvt_pk_bf16_f32 v98, v84, v85
    v_cvt_pk_bf16_f32 v99, v86, v87
    v_exp_f32 v90, v90
    v_exp_f32 v91, v91
    v_mfma_f32_32x32x16_bf16 v[160:175], v[208:211], v[220:223], v[160:175]
    buffer_load_dwordx4 v[204:207], v1, s[36:39], s21 offen offset:2048 sc1
    v_exp_f32 v92, v92
    v_exp_f32 v93, v93
    v_cvt_pk_bf16_f32 v100, v88, v89
    v_cvt_pk_bf16_f32 v101, v90, v91
    v_mfma_f32_32x32x16_bf16 v[44:59], v[116:119], v[96:99], v[44:59]
    s_lshl_b32 s6, s3, 11
    s_add_u32 s6, s6, 131072
    v_add_u32 v240, s6, v1
    v_xor_b32 v241, 8192, v240
    s_lshl_b32 s6, s3, 8
    s_add_u32 s6, s6, 147456
    v_lshl_add_u32 v242, v0, 2, s6
    v_or_b32 v243, 32, v0
    s_lshl_b32 s6, s52, 8
    s_add_u32 s6, s6, 147456
    v_lshl_add_u32 v243, v243, 2, s6
    s_mov_b32 s68, 528482304
    s_mov_b32 s69, 1602224128
    s_lshl_b32 s6, s4, 9
    s_add_u32 s6, s6, s5
    s_lshl_b32 s6, s6, 2
    s_add_u32 s6, s6, 13873152
    v_lshl_add_u32 v6, v0, 7, s6
    v_mov_b32 v7, s58
    buffer_load_dwordx4 v1, s[36:39], s29 offen offset:3072 sc1 lds
    v_exp_f32 v94, v94
    v_exp_f32 v95, v95
    v_cvt_pk_bf16_f32 v102, v92, v93
    v_cvt_pk_bf16_f32 v103, v94, v95
    v_exp_f32 v64, v64
    v_exp_f32 v65, v65
    s_waitcnt vmcnt(7) lgkmcnt(0)
    v_mfma_f32_32x32x16_bf16 v[44:59], v[120:123], v[100:103], v[44:59]
    ds_read_b128 v[120:123], v4 offset:11264
    v_exp_f32 v66, v66
    v_exp_f32 v67, v67
    v_exp_f32 v68, v68
    v_mfma_f32_32x32x16_bf16 v[128:143], v[224:227], v[232:235], v[128:143]
    buffer_load_dwordx4 v[208:211], v1, s[36:39], s19 offen offset:2048 sc1
    v_cvt_pk_bf16_f32 v96, v64, v65
    v_cvt_pk_bf16_f32 v97, v66, v67
    v_exp_f32 v69, v69
    v_exp_f32 v70, v70
    v_mfma_f32_32x32x16_bf16 v[80:95], v[104:107], v[36:39], 0
    ds_read_b128 v[116:119], v4 offset:14336
    v_exp_f32 v71, v71
    v_exp_f32 v72, v72
    v_exp_f32 v73, v73
    v_mfma_f32_32x32x16_bf16 v[80:95], v[108:111], v[40:43], v[80:95]
    v_cvt_pk_bf16_f32 v98, v68, v69
    v_cvt_pk_bf16_f32 v99, v70, v71
    v_exp_f32 v74, v74
    v_exp_f32 v75, v75
    v_mfma_f32_32x32x16_bf16 v[144:159], v[228:231], v[232:235], v[144:159]
    buffer_load_dwordx4 v[216:219], v1, s[36:39], s20 offen offset:3072 sc1
    v_exp_f32 v76, v76
    v_exp_f32 v77, v77
    v_cvt_pk_bf16_f32 v100, v72, v73
    v_cvt_pk_bf16_f32 v101, v74, v75
    v_mfma_f32_32x32x16_bf16 v[44:59], v[112:115], v[96:99], v[44:59]
    v_exp_f32 v78, v78
    v_exp_f32 v79, v79
    v_cvt_pk_bf16_f32 v102, v76, v77
    v_cvt_pk_bf16_f32 v103, v78, v79
    s_nop 1
    v_exp_f32 v80, v80
    v_exp_f32 v81, v81
    s_waitcnt lgkmcnt(0)
    v_mfma_f32_32x32x16_bf16 v[44:59], v[120:123], v[100:103], v[44:59]
    ds_read_b128 v[120:123], v4 offset:15360
    v_exp_f32 v82, v82
    v_exp_f32 v83, v83
    v_exp_f32 v84, v84
    v_mfma_f32_32x32x16_bf16 v[176:191], v[228:231], v[236:239], v[176:191]
    buffer_load_dwordx4 v[212:215], v1, s[36:39], s19 offen offset:3072 sc1
    s_add_u32 s19, s19, 4096
    v_cvt_pk_bf16_f32 v96, v80, v81
    v_cvt_pk_bf16_f32 v97, v82, v83
    v_exp_f32 v85, v85
    v_exp_f32 v86, v86
    v_exp_f32 v87, v87
    v_exp_f32 v88, v88
    v_exp_f32 v89, v89
    v_cvt_pk_bf16_f32 v98, v84, v85
    v_cvt_pk_bf16_f32 v99, v86, v87
    v_exp_f32 v90, v90
    v_exp_f32 v91, v91
    v_mfma_f32_32x32x16_bf16 v[160:175], v[224:227], v[236:239], v[160:175]
    buffer_load_dwordx4 v[220:223], v1, s[36:39], s21 offen offset:3072 sc1
    s_add_u32 s20, s20, 4096
    s_add_u32 s21, s21, 4096
    v_exp_f32 v92, v92
    v_exp_f32 v93, v93
    v_cvt_pk_bf16_f32 v100, v88, v89
    v_cvt_pk_bf16_f32 v101, v90, v91
    v_mfma_f32_32x32x16_bf16 v[44:59], v[116:119], v[96:99], v[44:59]
    v_exp_f32 v94, v94
    v_exp_f32 v95, v95
    v_cvt_pk_bf16_f32 v102, v92, v93
    v_cvt_pk_bf16_f32 v103, v94, v95
    s_nop 1
    s_waitcnt lgkmcnt(0)
    s_nop 0
    v_mfma_f32_32x32x16_bf16 v[44:59], v[120:123], v[100:103], v[44:59]
    s_cmp_eq_u32 s53, 0
    s_nop 10
    ds_write_b32 v242, v56
    s_cbranch_scc0 chi_27
    ds_write_b128 v240, v[52:55]
    ds_write_b128 v240, v[56:59] offset:1024
    s_branch cjn_28
chi_27:
    ds_write_b128 v240, v[44:47]
    ds_write_b128 v240, v[48:51] offset:1024
    s_waitcnt lgkmcnt(0)
    v_mov_b32 v44, v52
    v_mov_b32 v45, v53
    v_mov_b32 v46, v54
    v_mov_b32 v47, v55
    v_mov_b32 v48, v56
    v_mov_b32 v49, v57
    v_mov_b32 v50, v58
    v_mov_b32 v51, v59
cjn_28:
    s_waitcnt vmcnt(4) lgkmcnt(0)
    s_barrier
    ds_read2st64_b32 v[96:97], v243 offset0:0 offset1:4
    ds_read_b128 v[64:67], v241
    ds_read_b128 v[68:71], v241 offset:1024
    s_mov_b32 s66, 0
    s_sub_u32 s67, 0, s53
    s_waitcnt lgkmcnt(2)
    v_add_f32 v96, v96, v97
    v_rcp_f32 v97, v96
    v_cmp_nle_f32 vcc, s68, v96
    v_cmp_nge_f32 s[70:71], s69, v96
    s_waitcnt lgkmcnt(0)
    v_add_f32 v64, v64, v44
    v_add_f32 v65, v65, v45
    v_add_f32 v66, v66, v46
    v_add_f32 v67, v67, v47
    v_add_f32 v68, v68, v48
    v_add_f32 v69, v69, v49
    v_add_f32 v70, v70, v50
    v_add_f32 v71, v71, v51
    s_or_b64 s[70:71], s[70:71], vcc
    v_mul_f32 v64, v64, v97
    v_mul_f32 v65, v65, v97
    v_mul_f32 v66, v66, v97
    v_mul_f32 v67, v67, v97
    v_mul_f32 v68, v68, v97
    v_mul_f32 v69, v69, v97
    v_mul_f32 v70, v70, v97
    v_mul_f32 v71, v71, v97
    v_cvt_pk_bf16_f32 v104, v64, v65
    v_cvt_pk_bf16_f32 v105, v66, v67
    v_cvt_pk_bf16_f32 v106, v68, v69
    v_cvt_pk_bf16_f32 v107, v70, v71
    v_cndmask_b32 v106, v106, 0, s[66:67]
    v_cndmask_b32 v107, v107, 0, s[66:67]
    buffer_store_dwordx4 v[104:107], v1, s[36:39], s22 offen sc1
    v_add_f32 v98, |v64|, |v65|
    v_add_f32 v99, |v66|, |v67|
    v_add_f32 v100, |v68|, |v69|
    v_add_f32 v101, |v70|, |v71|
    v_add_f32 v98, v98, v99
    v_add_f32 v100, v100, v101
    s_mov_b32 s6, 0x7f7fffff
    v_add_f32 v98, v98, v100
    v_cmp_nge_f32 vcc, s6, v98
    s_nop 1
    s_or_b64 vcc, vcc, s[70:71]
    s_cbranch_vccnz cfb_29
cbk_30:
    v_mfma_f32_32x32x16_bf16 v[128:143], v[192:195], v[200:203], v[128:143]
    v_mfma_f32_32x32x16_bf16 v[144:159], v[196:199], v[200:203], v[144:159]
    v_mfma_f32_32x32x16_bf16 v[176:191], v[196:199], v[204:207], v[176:191]
    v_mfma_f32_32x32x16_bf16 v[160:175], v[192:195], v[204:207], v[160:175]
    s_waitcnt vmcnt(1)
    v_mfma_f32_32x32x16_bf16 v[128:143], v[208:211], v[216:219], v[128:143]
    v_mfma_f32_32x32x16_bf16 v[144:159], v[212:215], v[216:219], v[144:159]
    v_mfma_f32_32x32x16_bf16 v[176:191], v[212:215], v[220:223], v[176:191]
    v_mfma_f32_32x32x16_bf16 v[160:175], v[208:211], v[220:223], v[160:175]
    s_lshl_b32 s6, s3, 13
    s_add_u32 s6, s6, 32768
    v_add_u32 v254, s6, v1
    v_xor_b32 v255, 8192, v254
    s_nop 8
    s_lshr_b32 s6, s3, 1
    s_lshl_b32 s6, s6, 13
    v_add_u32 v243, s6, v1
    s_nop 0
    s_cmp_eq_u32 s3, 0
    s_cselect_b64 vcc, -1, 0
    s_waitcnt vmcnt(0)
    s_barrier
    s_cbranch_vccz os_31
    s_mov_b64 exec, 0xffff
    buffer_store_dword v7, v6, s[36:39], 0 offen sc1
    s_mov_b64 exec, -1
os_31:
    ds_write_b128 v254, v[160:163] offset:0
    s_lshr_b32 s6, s5, 3
    s_lshl_b32 s7, s4, 1
    s_add_u32 s6, s6, s7
    s_and_b32 s67, s3, 1
    s_lshl_b32 s68, s6, 1
    s_add_u32 s68, s68, s67
    ds_write_b128 v254, v[164:167] offset:1024
    s_mul_i32 s68, s68, 144
    s_lshr_b32 s66, s3, 1
    s_lshl_b32 s69, s66, 3
    s_add_u32 s69, s69, 112
    s_add_u32 s68, s68, s69
    s_lshl_b32 s68, s68, 10
    ds_write_b128 v254, v[168:171] offset:2048
    s_and_b32 s7, s5, 7
    s_add_u32 s69, s68, 4096
    s_lshl_b32 s66, s66, 14
    s_lshl_b32 s67, s67, 13
    s_add_u32 s72, s66, s67
    s_add_u32 s72, s72, 32768
    ds_write_b128 v254, v[172:175] offset:3072
    v_and_b32 v240, 31, v0
    v_lshrrev_b32 v241, 5, v0
    v_and_b32 v242, 7, v0
    v_xor_b32 v241, v241, v242
    v_lshlrev_b32 v241, 4, v241
    v_lshl_add_u32 v240, v240, 8, v241
    ds_write_b128 v254, v[176:179] offset:4096
    v_add_u32 v248, s72, v240
    v_xor_b32 v249, 32, v248
    v_xor_b32 v250, 64, v248
    v_xor_b32 v251, 96, v248
    s_lshl_b32 s6, s6, 6
    s_lshl_b32 s67, s3, 3
    ds_write_b128 v254, v[180:183] offset:5120
    s_add_u32 s6, s6, s67
    v_lshrrev_b32 v240, 3, v0
    v_add_u32 v241, s6, v240
    v_mul_u32_u24 v241, 896, v241
    v_lshl_add_u32 v241, v242, 4, v241
    s_lshl_b32 s7, s7, 7
    ds_write_b128 v254, v[184:187] offset:6144
    v_add_u32 v5, s7, v241
    v_lshlrev_b32 v242, 1, v242
    v_xor_b32 v242, v242, v240
    v_lshlrev_b32 v242, 4, v242
    v_lshl_add_u32 v240, v240, 8, v242
    s_lshl_b32 s6, s3, 11
    ds_write_b128 v254, v[188:191] offset:7168
    s_add_u32 s6, s6, 32768
    v_add_u32 v252, s6, v240
    v_xor_b32 v253, 16, v252
    v_add_u32 v242, 98304, v243
    buffer_load_dwordx4 v[244:247], v5, s[32:35], 0 offen
    s_waitcnt lgkmcnt(0)
    s_barrier
    ds_read_b128 v[64:67], v255 offset:0
    ds_read_b128 v[68:71], v255 offset:1024
    ds_read_b128 v[72:75], v255 offset:2048
    ds_read_b128 v[76:79], v255 offset:3072
    ds_read_b128 v[80:83], v255 offset:4096
    ds_read_b128 v[84:87], v255 offset:5120
    ds_read_b128 v[88:91], v255 offset:6144
    ds_read_b128 v[92:95], v255 offset:7168
    s_mov_b32 s40, s26
    s_mov_b32 s41, s27
    s_mov_b32 s42, 1835008
    s_mov_b32 s43, 0x00020000
    s_waitcnt lgkmcnt(7)
    v_add_f32 v128, v128, v64
    v_add_f32 v129, v129, v65
    v_add_f32 v130, v130, v66
    v_add_f32 v131, v131, v67
    s_waitcnt lgkmcnt(6)
    v_add_f32 v132, v132, v68
    v_add_f32 v133, v133, v69
    v_add_f32 v134, v134, v70
    v_add_f32 v135, v135, v71
    s_waitcnt lgkmcnt(5)
    v_add_f32 v136, v136, v72
    v_add_f32 v137, v137, v73
    v_add_f32 v138, v138, v74
    v_add_f32 v139, v139, v75
    s_waitcnt lgkmcnt(4)
    v_add_f32 v140, v140, v76
    v_add_f32 v141, v141, v77
    v_add_f32 v142, v142, v78
    v_add_f32 v143, v143, v79
    s_waitcnt lgkmcnt(3)
    v_add_f32 v144, v144, v80
    v_add_f32 v145, v145, v81
    v_add_f32 v146, v146, v82
    v_add_f32 v147, v147, v83
    s_waitcnt lgkmcnt(2)
    v_add_f32 v148, v148, v84
    v_add_f32 v149, v149, v85
    v_add_f32 v150, v150, v86
    v_add_f32 v151, v151, v87
    s_waitcnt lgkmcnt(1)
    v_add_f32 v152, v152, v88
    v_add_f32 v153, v153, v89
    v_add_f32 v154, v154, v90
    v_add_f32 v155, v155, v91
    s_waitcnt lgkmcnt(0)
    v_add_f32 v156, v156, v92
    v_add_f32 v157, v157, v93
    v_add_f32 v158, v158, v94
    v_add_f32 v159, v159, v95
    s_cmp_eq_u32 s3, 0
    s_cbranch_scc0 pi_32
    s_lshl_b32 s6, s4, 4
    s_add_u32 s6, s6, s5
    s_lshl_b32 s6, s6, 7
    s_add_u32 s6, s6, 13873152
    v_and_b32 v240, 15, v0
    v_lshl_add_u32 v240, v240, 2, s6
    buffer_load_dword v241, v240, s[36:39], 0 offen sc1
pi_32:
    s_cmp_eq_u32 s3, 0
    s_cbranch_scc0 pok_33
    s_waitcnt vmcnt(0)
    v_cmp_ne_u32 vcc, s58, v241
    s_cbranch_vccz pok_33
    s_mov_b32 s74, 2097152
psp_34:
    s_sleep 1
    buffer_load_dword v241, v240, s[36:39], 0 offen sc1
    s_sub_u32 s74, s74, 1
    s_waitcnt vmcnt(0)
    v_cmp_ne_u32 vcc, s58, v241
    s_cmp_eq_u32 s74, 0
    s_cbranch_scc1 pok_33
    s_cbranch_vccnz psp_34
pok_33:
    s_barrier
    buffer_load_dwordx4 v[96:99], v1, s[36:39], s68 offen offset:0 sc1
    buffer_load_dwordx4 v[100:103], v1, s[36:39], s68 offen offset:1024 sc1
    buffer_load_dwordx4 v[104:107], v1, s[36:39], s68 offen offset:2048 sc1
    buffer_load_dwordx4 v[108:111], v1, s[36:39], s68 offen offset:3072 sc1
    buffer_load_dwordx4 v[112:115], v1, s[36:39], s69 offen offset:0 sc1
    buffer_load_dwordx4 v[116:119], v1, s[36:39], s69 offen offset:1024 sc1
    buffer_load_dwordx4 v[120:123], v1, s[36:39], s69 offen offset:2048 sc1
    buffer_load_dwordx4 v[36:39], v1, s[36:39], s69 offen offset:3072 sc1
    ds_read_b128 v[8:11], v242 offset:0
    ds_read_b128 v[12:15], v242 offset:1024
    ds_read_b128 v[16:19], v242 offset:2048
    ds_read_b128 v[20:23], v242 offset:3072
    ds_read_b128 v[24:27], v242 offset:4096
    ds_read_b128 v[28:31], v242 offset:5120
    ds_read_b128 v[32:35], v242 offset:6144
    ds_read_b128 v[192:195], v242 offset:7168
    ds_read_b128 v[196:199], v243 offset:0
    ds_read_b128 v[200:203], v243 offset:1024
    ds_read_b128 v[204:207], v243 offset:2048
    ds_read_b128 v[208:211], v243 offset:3072
    ds_read_b128 v[212:215], v243 offset:4096
    ds_read_b128 v[216:219], v243 offset:5120
    ds_read_b128 v[220:223], v243 offset:6144
    ds_read_b128 v[224:227], v243 offset:7168
    s_waitcnt lgkmcnt(0)
    s_waitcnt vmcnt(8)
    v_lshlrev_b32 v232, 16, v244
    v_and_b32 v233, s49, v244
    v_lshlrev_b32 v234, 16, v245
    v_and_b32 v235, s49, v245
    v_lshlrev_b32 v236, 16, v246
    v_and_b32 v237, s49, v246
    v_lshlrev_b32 v238, 16, v247
    v_and_b32 v239, s49, v247
    s_waitcnt vmcnt(7)
    v_mfma_f32_32x32x16_bf16 v[128:143], v[8:11], v[96:99], v[128:143]
    v_mfma_f32_32x32x16_bf16 v[144:159], v[12:15], v[96:99], v[144:159]
    s_waitcnt vmcnt(6)
    v_mfma_f32_32x32x16_bf16 v[128:143], v[16:19], v[100:103], v[128:143]
    v_mfma_f32_32x32x16_bf16 v[144:159], v[20:23], v[100:103], v[144:159]
    s_waitcnt vmcnt(5)
    v_mfma_f32_32x32x16_bf16 v[128:143], v[24:27], v[104:107], v[128:143]
    v_mfma_f32_32x32x16_bf16 v[144:159], v[28:31], v[104:107], v[144:159]
    s_waitcnt vmcnt(4)
    v_mfma_f32_32x32x16_bf16 v[128:143], v[32:35], v[108:111], v[128:143]
    v_mfma_f32_32x32x16_bf16 v[144:159], v[192:195], v[108:111], v[144:159]
    s_waitcnt vmcnt(3)
    v_mfma_f32_32x32x16_bf16 v[128:143], v[196:199], v[112:115], v[128:143]
    v_mfma_f32_32x32x16_bf16 v[144:159], v[200:203], v[112:115], v[144:159]
    s_waitcnt vmcnt(2)
    v_mfma_f32_32x32x16_bf16 v[128:143], v[204:207], v[116:119], v[128:143]
    v_mfma_f32_32x32x16_bf16 v[144:159], v[208:211], v[116:119], v[144:159]
    s_waitcnt vmcnt(1)
    v_mfma_f32_32x32x16_bf16 v[128:143], v[212:215], v[120:123], v[128:143]
    v_mfma_f32_32x32x16_bf16 v[144:159], v[216:219], v[120:123], v[144:159]
    s_waitcnt vmcnt(0)
    v_mfma_f32_32x32x16_bf16 v[128:143], v[220:223], v[36:39], v[128:143]
    v_mfma_f32_32x32x16_bf16 v[144:159], v[224:227], v[36:39], v[144:159]
    s_nop 10
    ds_write_b128 v248, v[128:131] offset:0
    ds_write_b128 v249, v[132:135] offset:0
    ds_write_b128 v250, v[136:139] offset:0
    ds_write_b128 v251, v[140:143] offset:0
    ds_write_b128 v248, v[144:147] offset:128
    ds_write_b128 v249, v[148:151] offset:128
    ds_write_b128 v250, v[152:155] offset:128
    ds_write_b128 v251, v[156:159] offset:128
    s_waitcnt lgkmcnt(0)
    s_barrier
    ds_read_b128 v[64:67], v252 offset:0
    ds_read_b128 v[68:71], v253 offset:0
    ds_read_b128 v[72:75], v252 offset:16384
    ds_read_b128 v[76:79], v253 offset:16384
    ds_read_b128 v[80:83], v252 offset:32768
    ds_read_b128 v[84:87], v253 offset:32768
    ds_read_b128 v[88:91], v252 offset:49152
    ds_read_b128 v[92:95], v253 offset:49152
    s_waitcnt lgkmcnt(6)
    v_add_f32 v232, v232, v64
    v_add_f32 v233, v233, v65
    v_add_f32 v234, v234, v66
    v_add_f32 v235, v235, v67
    v_add_f32 v236, v236, v68
    v_add_f32 v237, v237, v69
    v_add_f32 v238, v238, v70
    v_add_f32 v239, v239, v71
    s_waitcnt lgkmcnt(4)
    v_add_f32 v232, v232, v72
    v_add_f32 v233, v233, v73
    v_add_f32 v234, v234, v74
    v_add_f32 v235, v235, v75
    v_add_f32 v236, v236, v76
    v_add_f32 v237, v237, v77
    v_add_f32 v238, v238, v78
    v_add_f32 v239, v239, v79
    s_waitcnt lgkmcnt(2)
    v_add_f32 v232, v232, v80
    v_add_f32 v233, v233, v81
    v_add_f32 v234, v234, v82
    v_add_f32 v235, v235, v83
    v_add_f32 v236, v236, v84
    v_add_f32 v237, v237, v85
    v_add_f32 v238, v238, v86
    v_add_f32 v239, v239, v87
    s_waitcnt lgkmcnt(0)
    v_add_f32 v232, v232, v88
    v_add_f32 v233, v233, v89
    v_add_f32 v234, v234, v90
    v_add_f32 v235, v235, v91
    v_add_f32 v236, v236, v92
    v_add_f32 v237, v237, v93
    v_add_f32 v238, v238, v94
    v_add_f32 v239, v239, v95
    v_cvt_pk_bf16_f32 v244, v232, v233
    v_cvt_pk_bf16_f32 v245, v234, v235
    v_cvt_pk_bf16_f32 v246, v236, v237
    v_cvt_pk_bf16_f32 v247, v238, v239
    buffer_store_dwordx4 v[244:247], v5, s[40:43], 0 offen
    s_branch K_fin
C_noF:
    s_cmp_ge_u32 s3, 4
    s_cbranch_scc0 np_35
    s_setprio 1
np_35:
    s_waitcnt vmcnt(4)
    s_barrier
    ds_read_b128 v[104:107], v4 offset:32768
    ds_read_b128 v[108:111], v4 offset:33792
    ds_read_b128 v[112:115], v4 offset:34816
    s_waitcnt lgkmcnt(1)
    v_mfma_f32_32x32x16_bf16 v[64:79], v[104:107], v[36:39], 0
    v_mfma_f32_32x32x16_bf16 v[64:79], v[108:111], v[40:43], v[64:79]
    ds_read_b128 v[104:107], v4 offset:36864
    ds_read_b128 v[108:111], v4 offset:37888
    s_nop 9
    v_exp_f32 v64, v64
    v_exp_f32 v65, v65
    s_waitcnt lgkmcnt(0)
    ds_read_b128 v[120:123], v4 offset:35840
    v_exp_f32 v66, v66
    v_exp_f32 v67, v67
    v_exp_f32 v68, v68
    v_cvt_pk_bf16_f32 v96, v64, v65
    v_cvt_pk_bf16_f32 v97, v66, v67
    v_exp_f32 v69, v69
    v_exp_f32 v70, v70
    v_mfma_f32_32x32x16_bf16 v[80:95], v[104:107], v[36:39], 0
    ds_read_b128 v[116:119], v4 offset:38912
    v_exp_f32 v71, v71
    v_exp_f32 v72, v72
    v_exp_f32 v73, v73
    v_mfma_f32_32x32x16_bf16 v[80:95], v[108:111], v[40:43], v[80:95]
    ds_read_b128 v[104:107], v4 offset:40960
    ds_read_b128 v[108:111], v4 offset:41984
    s_add_u32 m0, s18, 32768
    s_nop 0
    v_cvt_pk_bf16_f32 v98, v68, v69
    v_cvt_pk_bf16_f32 v99, v70, v71
    v_exp_f32 v74, v74
    v_exp_f32 v75, v75
    v_exp_f32 v76, v76
    v_exp_f32 v77, v77
    v_cvt_pk_bf16_f32 v100, v72, v73
    v_cvt_pk_bf16_f32 v101, v74, v75
    v_mfma_f32_32x32x16_bf16 v[44:59], v[112:115], v[96:99], 0
    buffer_load_dwordx4 v1, s[36:39], s15 offen offset:0 sc1 lds
    buffer_load_dwordx4 v1, s[36:39], s15 offen offset:1024 sc1 lds
    v_exp_f32 v78, v78
    v_exp_f32 v79, v79
    v_cvt_pk_bf16_f32 v102, v76, v77
    v_cvt_pk_bf16_f32 v103, v78, v79
    v_exp_f32 v80, v80
    v_exp_f32 v81, v81
    s_waitcnt lgkmcnt(0)
    v_mfma_f32_32x32x16_bf16 v[44:59], v[120:123], v[100:103], v[44:59]
    ds_read_b128 v[120:123], v4 offset:39936
    v_exp_f32 v82, v82
    v_exp_f32 v83, v83
    v_exp_f32 v84, v84
    v_cvt_pk_bf16_f32 v96, v80, v81
    v_cvt_pk_bf16_f32 v97, v82, v83
    v_exp_f32 v85, v85
    v_exp_f32 v86, v86
    v_mfma_f32_32x32x16_bf16 v[64:79], v[104:107], v[36:39], 0
    ds_read_b128 v[112:115], v4 offset:43008
    v_exp_f32 v87, v87
    v_exp_f32 v88, v88
    v_exp_f32 v89, v89
    v_mfma_f32_32x32x16_bf16 v[64:79], v[108:111], v[40:43], v[64:79]
    ds_read_b128 v[104:107], v4 offset:45056
    ds_read_b128 v[108:111], v4 offset:46080
    v_cvt_pk_bf16_f32 v98, v84, v85
    v_cvt_pk_bf16_f32 v99, v86, v87
    v_exp_f32 v90, v90
    v_exp_f32 v91, v91
    v_exp_f32 v92, v92
    v_exp_f32 v93, v93
    v_cvt_pk_bf16_f32 v100, v88, v89
    v_cvt_pk_bf16_f32 v101, v90, v91
    v_mfma_f32_32x32x16_bf16 v[44:59], v[116:119], v[96:99], v[44:59]
    buffer_load_dwordx4 v1, s[36:39], s15 offen offset:2048 sc1 lds
    buffer_load_dwordx4 v1, s[36:39], s15 offen offset:3072 sc1 lds
    s_add_u32 s15, s15, 16384
    buffer_store_dwordx4 v[16:19], v1, s[36:39], s12 offen offset:0 sc1
    v_exp_f32 v94, v94
    v_exp_f32 v95, v95
    v_cvt_pk_bf16_f32 v102, v92, v93
    v_cvt_pk_bf16_f32 v103, v94, v95
    v_exp_f32 v64, v64
    v_exp_f32 v65, v65
    s_waitcnt lgkmcnt(0)
    v_mfma_f32_32x32x16_bf16 v[44:59], v[120:123], v[100:103], v[44:59]
    ds_read_b128 v[120:123], v4 offset:44032
    v_exp_f32 v66, v66
    v_exp_f32 v67, v67
    v_exp_f32 v68, v68
    v_cvt_pk_bf16_f32 v96, v64, v65
    v_cvt_pk_bf16_f32 v97, v66, v67
    v_exp_f32 v69, v69
    v_exp_f32 v70, v70
    v_mfma_f32_32x32x16_bf16 v[80:95], v[104:107], v[36:39], 0
    ds_read_b128 v[116:119], v4 offset:47104
    v_exp_f32 v71, v71
    v_exp_f32 v72, v72
    v_exp_f32 v73, v73
    v_mfma_f32_32x32x16_bf16 v[80:95], v[108:111], v[40:43], v[80:95]
    s_waitcnt vmcnt(5)
    s_barrier
    ds_read_b128 v[104:107], v3 offset:0
    ds_read_b128 v[108:111], v3 offset:1024
    s_add_u32 m0, s18, 65536
    v_cvt_pk_bf16_f32 v98, v68, v69
    v_cvt_pk_bf16_f32 v99, v70, v71
    v_exp_f32 v74, v74
    v_exp_f32 v75, v75
    v_exp_f32 v76, v76
    v_exp_f32 v77, v77
    v_cvt_pk_bf16_f32 v100, v72, v73
    v_cvt_pk_bf16_f32 v101, v74, v75
    v_mfma_f32_32x32x16_bf16 v[44:59], v[112:115], v[96:99], v[44:59]
    buffer_load_dwordx4 v1, s[36:39], s15 offen offset:0 sc1 lds
    buffer_store_dwordx4 v[20:23], v1, s[36:39], s12 offen offset:1024 sc1
    v_exp_f32 v78, v78
    v_exp_f32 v79, v79
    v_cvt_pk_bf16_f32 v102, v76, v77
    v_cvt_pk_bf16_f32 v103, v78, v79
    v_exp_f32 v80, v80
    v_exp_f32 v81, v81
    s_waitcnt lgkmcnt(0)
    v_mfma_f32_32x32x16_bf16 v[44:59], v[120:123], v[100:103], v[44:59]
    ds_read_b128 v[120:123], v4 offset:48128
    v_exp_f32 v82, v82
    v_exp_f32 v83, v83
    v_exp_f32 v84, v84
    v_cvt_pk_bf16_f32 v96, v80, v81
    v_cvt_pk_bf16_f32 v97, v82, v83
    v_exp_f32 v85, v85
    v_exp_f32 v86, v86
    v_mfma_f32_32x32x16_bf16 v[64:79], v[104:107], v[36:39], 0
    ds_read_b128 v[112:115], v3 offset:2048
    v_exp_f32 v87, v87
    v_exp_f32 v88, v88
    v_exp_f32 v89, v89
    v_mfma_f32_32x32x16_bf16 v[64:79], v[108:111], v[40:43], v[64:79]
    ds_read_b128 v[104:107], v3 offset:4096
    ds_read_b128 v[108:111], v3 offset:5120
    v_cvt_pk_bf16_f32 v98, v84, v85
    v_cvt_pk_bf16_f32 v99, v86, v87
    v_exp_f32 v90, v90
    v_exp_f32 v91, v91
    v_exp_f32 v92, v92
    v_exp_f32 v93, v93
    v_cvt_pk_bf16_f32 v100, v88, v89
    v_cvt_pk_bf16_f32 v101, v90, v91
    v_mfma_f32_32x32x16_bf16 v[44:59], v[116:119], v[96:99], v[44:59]
    buffer_load_dwordx4 v1, s[36:39], s15 offen offset:1024 sc1 lds
    v_exp_f32 v94, v94
    v_exp_f32 v95, v95
    v_cvt_pk_bf16_f32 v102, v92, v93
    v_cvt_pk_bf16_f32 v103, v94, v95
    v_exp_f32 v64, v64
    v_exp_f32 v65, v65
    s_waitcnt lgkmcnt(0)
    v_mfma_f32_32x32x16_bf16 v[44:59], v[120:123], v[100:103], v[44:59]
    ds_read_b128 v[120:123], v3 offset:3072
    v_exp_f32 v66, v66
    v_exp_f32 v67, v67
    v_exp_f32 v68, v68
    v_cvt_pk_bf16_f32 v96, v64, v65
    v_cvt_pk_bf16_f32 v97, v66, v67
    v_exp_f32 v69, v69
    v_exp_f32 v70, v70
    v_mfma_f32_32x32x16_bf16 v[80:95], v[104:107], v[36:39], 0
    ds_read_b128 v[116:119], v3 offset:6144
    v_exp_f32 v71, v71
    v_exp_f32 v72, v72
    v_exp_f32 v73, v73
    v_mfma_f32_32x32x16_bf16 v[80:95], v[108:111], v[40:43], v[80:95]
    ds_read_b128 v[104:107], v3 offset:8192
    ds_read_b128 v[108:111], v3 offset:9216
    v_cvt_pk_bf16_f32 v98, v68, v69
    v_cvt_pk_bf16_f32 v99, v70, v71
    v_exp_f32 v74, v74
    v_exp_f32 v75, v75
    v_exp_f32 v76, v76
    v_exp_f32 v77, v77
    v_cvt_pk_bf16_f32 v100, v72, v73
    v_cvt_pk_bf16_f32 v101, v74, v75
    v_mfma_f32_32x32x16_bf16 v[44:59], v[112:115], v[96:99], v[44:59]
    buffer_load_dwordx4 v1, s[36:39], s15 offen offset:2048 sc1 lds
    v_exp_f32 v78, v78
    v_exp_f32 v79, v79
    v_cvt_pk_bf16_f32 v102, v76, v77
    v_cvt_pk_bf16_f32 v103, v78, v79
    v_exp_f32 v80, v80
    v_exp_f32 v81, v81
    s_waitcnt lgkmcnt(0)
    v_mfma_f32_32x32x16_bf16 v[44:59], v[120:123], v[100:103], v[44:59]
    ds_read_b128 v[120:123], v3 offset:7168
    v_exp_f32 v82, v82
    v_exp_f32 v83, v83
    v_exp_f32 v84, v84
    v_cvt_pk_bf16_f32 v96, v80, v81
    v_cvt_pk_bf16_f32 v97, v82, v83
    v_exp_f32 v85, v85
    v_exp_f32 v86, v86
    v_mfma_f32_32x32x16_bf16 v[64:79], v[104:107], v[36:39], 0
    ds_read_b128 v[112:115], v3 offset:10240
    v_exp_f32 v87, v87
    v_exp_f32 v88, v88
    v_exp_f32 v89, v89
    v_mfma_f32_32x32x16_bf16 v[64:79], v[108:111], v[40:43], v[64:79]
    ds_read_b128 v[104:107], v3 offset:12288
    ds_read_b128 v[108:111], v3 offset:13312
    v_cvt_pk_bf16_f32 v98, v84, v85
    v_cvt_pk_bf16_f32 v99, v86, v87
    v_exp_f32 v90, v90
    v_exp_f32 v91, v91
    v_exp_f32 v92, v92
    v_exp_f32 v93, v93
    v_cvt_pk_bf16_f32 v100, v88, v89
    v_cvt_pk_bf16_f32 v101, v90, v91
    v_mfma_f32_32x32x16_bf16 v[44:59], v[116:119], v[96:99], v[44:59]
    buffer_load_dwordx4 v1, s[36:39], s15 offen offset:3072 sc1 lds
    s_add_u32 s15, s15, 16384
    v_exp_f32 v94, v94
    v_exp_f32 v95, v95
    v_cvt_pk_bf16_f32 v102, v92, v93
    v_cvt_pk_bf16_f32 v103, v94, v95
    v_exp_f32 v64, v64
    v_exp_f32 v65, v65
    s_waitcnt lgkmcnt(0)
    v_mfma_f32_32x32x16_bf16 v[44:59], v[120:123], v[100:103], v[44:59]
    ds_read_b128 v[120:123], v3 offset:11264
    v_exp_f32 v66, v66
    v_exp_f32 v67, v67
    v_exp_f32 v68, v68
    v_cvt_pk_bf16_f32 v96, v64, v65
    v_cvt_pk_bf16_f32 v97, v66, v67
    v_exp_f32 v69, v69
    v_exp_f32 v70, v70
    v_mfma_f32_32x32x16_bf16 v[80:95], v[104:107], v[36:39], 0
    ds_read_b128 v[116:119], v3 offset:14336
    v_exp_f32 v71, v71
    v_exp_f32 v72, v72
    v_exp_f32 v73, v73
    v_mfma_f32_32x32x16_bf16 v[80:95], v[108:111], v[40:43], v[80:95]
    s_waitcnt vmcnt(3)
    s_barrier
    s_cmp_eq_u32 s3, 0
    s_cbranch_scc0 fl_36
    s_lshl_b32 s6, s4, 5
    s_add_u32 s6, s6, s5
    s_lshl_b32 s6, s6, 2
    s_add_u32 s6, s6, 13862912
    v_mov_b32 v242, s6
    v_mov_b32 v243, s58
    s_mov_b64 exec, 1
    buffer_store_dword v243, v242, s[36:39], 0 offen sc1
    s_mov_b64 exec, -1
fl_36:
    ds_read_b128 v[104:107], v3 offset:32768
    ds_read_b128 v[108:111], v3 offset:33792
    s_add_u32 m0, s18, 98304
    v_cvt_pk_bf16_f32 v98, v68, v69
    v_cvt_pk_bf16_f32 v99, v70, v71
    v_exp_f32 v74, v74
    v_exp_f32 v75, v75
    v_exp_f32 v76, v76
    v_exp_f32 v77, v77
    v_cvt_pk_bf16_f32 v100, v72, v73
    v_cvt_pk_bf16_f32 v101, v74, v75
    v_mfma_f32_32x32x16_bf16 v[44:59], v[112:115], v[96:99], v[44:59]
    buffer_load_dwordx4 v1, s[36:39], s15 offen offset:0 sc1 lds
    v_exp_f32 v78, v78
    v_exp_f32 v79, v79
    v_cvt_pk_bf16_f32 v102, v76, v77
    v_cvt_pk_bf16_f32 v103, v78, v79
    v_exp_f32 v80, v80
    v_exp_f32 v81, v81
    s_waitcnt lgkmcnt(0)
    v_mfma_f32_32x32x16_bf16 v[44:59], v[120:123], v[100:103], v[44:59]
    ds_read_b128 v[120:123], v3 offset:15360
    v_exp_f32 v82, v82
    v_exp_f32 v83, v83
    v_exp_f32 v84, v84
    v_cvt_pk_bf16_f32 v96, v80, v81
    v_cvt_pk_bf16_f32 v97, v82, v83
    v_exp_f32 v85, v85
    v_exp_f32 v86, v86
    v_mfma_f32_32x32x16_bf16 v[64:79], v[104:107], v[36:39], 0
    ds_read_b128 v[112:115], v3 offset:34816
    v_exp_f32 v87, v87
    v_exp_f32 v88, v88
    v_exp_f32 v89, v89
    v_mfma_f32_32x32x16_bf16 v[64:79], v[108:111], v[40:43], v[64:79]
    ds_read_b128 v[104:107], v3 offset:36864
    ds_read_b128 v[108:111], v3 offset:37888
    v_cvt_pk_bf16_f32 v98, v84, v85
    v_cvt_pk_bf16_f32 v99, v86, v87
    v_exp_f32 v90, v90
    v_exp_f32 v91, v91
    v_exp_f32 v92, v92
    v_exp_f32 v93, v93
    v_cvt_pk_bf16_f32 v100, v88, v89
    v_cvt_pk_bf16_f32 v101, v90, v91
    v_mfma_f32_32x32x16_bf16 v[44:59], v[116:119], v[96:99], v[44:59]
    buffer_load_dwordx4 v1, s[36:39], s15 offen offset:1024 sc1 lds
    v_exp_f32 v94, v94
    v_exp_f32 v95, v95
    v_cvt_pk_bf16_f32 v102, v92, v93
    v_cvt_pk_bf16_f32 v103, v94, v95
    v_exp_f32 v64, v64
    v_exp_f32 v65, v65
    s_waitcnt lgkmcnt(0)
    v_mfma_f32_32x32x16_bf16 v[44:59], v[120:123], v[100:103], v[44:59]
    ds_read_b128 v[120:123], v3 offset:35840
    v_exp_f32 v66, v66
    v_exp_f32 v67, v67
    v_exp_f32 v68, v68
    v_cvt_pk_bf16_f32 v96, v64, v65
    v_cvt_pk_bf16_f32 v97, v66, v67
    v_exp_f32 v69, v69
    v_exp_f32 v70, v70
    v_mfma_f32_32x32x16_bf16 v[80:95], v[104:107], v[36:39], 0
    ds_read_b128 v[116:119], v3 offset:38912
    v_exp_f32 v71, v71
    v_exp_f32 v72, v72
    v_exp_f32 v73, v73
    v_mfma_f32_32x32x16_bf16 v[80:95], v[108:111], v[40:43], v[80:95]
    ds_read_b128 v[104:107], v3 offset:40960
    ds_read_b128 v[108:111], v3 offset:41984
    v_cvt_pk_bf16_f32 v98, v68, v69
    v_cvt_pk_bf16_f32 v99, v70, v71
    v_exp_f32 v74, v74
    v_exp_f32 v75, v75
    v_exp_f32 v76, v76
    v_exp_f32 v77, v77
    v_cvt_pk_bf16_f32 v100, v72, v73
    v_cvt_pk_bf16_f32 v101, v74, v75
    v_mfma_f32_32x32x16_bf16 v[44:59], v[112:115], v[96:99], v[44:59]
    buffer_load_dwordx4 v1, s[36:39], s15 offen offset:2048 sc1 lds
    v_exp_f32 v78, v78
    v_exp_f32 v79, v79
    v_cvt_pk_bf16_f32 v102, v76, v77
    v_cvt_pk_bf16_f32 v103, v78, v79
    v_exp_f32 v80, v80
    v_exp_f32 v81, v81
    s_waitcnt lgkmcnt(0)
    v_mfma_f32_32x32x16_bf16 v[44:59], v[120:123], v[100:103], v[44:59]
    ds_read_b128 v[120:123], v3 offset:39936
    v_exp_f32 v82, v82
    v_exp_f32 v83, v83
    v_exp_f32 v84, v84
    v_cvt_pk_bf16_f32 v96, v80, v81
    v_cvt_pk_bf16_f32 v97, v82, v83
    v_exp_f32 v85, v85
    v_exp_f32 v86, v86
    v_mfma_f32_32x32x16_bf16 v[64:79], v[104:107], v[36:39], 0
    ds_read_b128 v[112:115], v3 offset:43008
    v_exp_f32 v87, v87
    v_exp_f32 v88, v88
    v_exp_f32 v89, v89
    v_mfma_f32_32x32x16_bf16 v[64:79], v[108:111], v[40:43], v[64:79]
    ds_read_b128 v[104:107], v3 offset:45056
    ds_read_b128 v[108:111], v3 offset:46080
    v_cvt_pk_bf16_f32 v98, v84, v85
    v_cvt_pk_bf16_f32 v99, v86, v87
    v_exp_f32 v90, v90
    v_exp_f32 v91, v91
    v_exp_f32 v92, v92
    v_exp_f32 v93, v93
    v_cvt_pk_bf16_f32 v100, v88, v89
    v_cvt_pk_bf16_f32 v101, v90, v91
    v_mfma_f32_32x32x16_bf16 v[44:59], v[116:119], v[96:99], v[44:59]
    buffer_load_dwordx4 v1, s[36:39], s15 offen offset:3072 sc1 lds
    s_add_u32 s15, s15, 16384
    v_exp_f32 v94, v94
    v_exp_f32 v95, v95
    v_cvt_pk_bf16_f32 v102, v92, v93
    v_cvt_pk_bf16_f32 v103, v94, v95
    v_exp_f32 v64, v64
    v_exp_f32 v65, v65
    s_waitcnt lgkmcnt(0)
    v_mfma_f32_32x32x16_bf16 v[44:59], v[120:123], v[100:103], v[44:59]
    ds_read_b128 v[120:123], v3 offset:44032
    v_exp_f32 v66, v66
    v_exp_f32 v67, v67
    v_exp_f32 v68, v68
    v_cvt_pk_bf16_f32 v96, v64, v65
    v_cvt_pk_bf16_f32 v97, v66, v67
    v_exp_f32 v69, v69
    v_exp_f32 v70, v70
    v_mfma_f32_32x32x16_bf16 v[80:95], v[104:107], v[36:39], 0
    ds_read_b128 v[116:119], v3 offset:47104
    v_exp_f32 v71, v71
    v_exp_f32 v72, v72
    v_exp_f32 v73, v73
    v_mfma_f32_32x32x16_bf16 v[80:95], v[108:111], v[40:43], v[80:95]
    s_waitcnt vmcnt(4)
    s_barrier
    ds_read_b128 v[104:107], v4 offset:0
    ds_read_b128 v[108:111], v4 offset:1024
    s_add_u32 m0, s18, 0
    v_cvt_pk_bf16_f32 v98, v68, v69
    v_cvt_pk_bf16_f32 v99, v70, v71
    v_exp_f32 v74, v74
    v_exp_f32 v75, v75
    v_exp_f32 v76, v76
    v_exp_f32 v77, v77
    v_cvt_pk_bf16_f32 v100, v72, v73
    v_cvt_pk_bf16_f32 v101, v74, v75
    v_mfma_f32_32x32x16_bf16 v[44:59], v[112:115], v[96:99], v[44:59]
    buffer_load_dwordx4 v1, s[36:39], s15 offen offset:0 sc1 lds
    v_exp_f32 v78, v78
    v_exp_f32 v79, v79
    v_cvt_pk_bf16_f32 v102, v76, v77
    v_cvt_pk_bf16_f32 v103, v78, v79
    v_exp_f32 v80, v80
    v_exp_f32 v81, v81
    s_waitcnt lgkmcnt(0)
    v_mfma_f32_32x32x16_bf16 v[44:59], v[120:123], v[100:103], v[44:59]
    ds_read_b128 v[120:123], v3 offset:48128
    v_exp_f32 v82, v82
    v_exp_f32 v83, v83
    v_exp_f32 v84, v84
    v_cvt_pk_bf16_f32 v96, v80, v81
    v_cvt_pk_bf16_f32 v97, v82, v83
    v_exp_f32 v85, v85
    v_exp_f32 v86, v86
    v_mfma_f32_32x32x16_bf16 v[64:79], v[104:107], v[36:39], 0
    ds_read_b128 v[112:115], v4 offset:2048
    v_exp_f32 v87, v87
    v_exp_f32 v88, v88
    v_exp_f32 v89, v89
    v_mfma_f32_32x32x16_bf16 v[64:79], v[108:111], v[40:43], v[64:79]
    ds_read_b128 v[104:107], v4 offset:4096
    ds_read_b128 v[108:111], v4 offset:5120
    v_cvt_pk_bf16_f32 v98, v84, v85
    v_cvt_pk_bf16_f32 v99, v86, v87
    v_exp_f32 v90, v90
    v_exp_f32 v91, v91
    v_exp_f32 v92, v92
    v_exp_f32 v93, v93
    v_cvt_pk_bf16_f32 v100, v88, v89
    v_cvt_pk_bf16_f32 v101, v90, v91
    v_mfma_f32_32x32x16_bf16 v[44:59], v[116:119], v[96:99], v[44:59]
    buffer_load_dwordx4 v1, s[36:39], s15 offen offset:1024 sc1 lds
    v_exp_f32 v94, v94
    v_exp_f32 v95, v95
    v_cvt_pk_bf16_f32 v102, v92, v93
    v_cvt_pk_bf16_f32 v103, v94, v95
    v_exp_f32 v64, v64
    v_exp_f32 v65, v65
    s_waitcnt lgkmcnt(0)
    v_mfma_f32_32x32x16_bf16 v[44:59], v[120:123], v[100:103], v[44:59]
    ds_read_b128 v[120:123], v4 offset:3072
    v_exp_f32 v66, v66
    v_exp_f32 v67, v67
    v_exp_f32 v68, v68
    v_cvt_pk_bf16_f32 v96, v64, v65
    v_cvt_pk_bf16_f32 v97, v66, v67
    v_exp_f32 v69, v69
    v_exp_f32 v70, v70
    v_mfma_f32_32x32x16_bf16 v[80:95], v[104:107], v[36:39], 0
    ds_read_b128 v[116:119], v4 offset:6144
    v_exp_f32 v71, v71
    v_exp_f32 v72, v72
    v_exp_f32 v73, v73
    v_mfma_f32_32x32x16_bf16 v[80:95], v[108:111], v[40:43], v[80:95]
    ds_read_b128 v[104:107], v4 offset:8192
    ds_read_b128 v[108:111], v4 offset:9216
    v_cvt_pk_bf16_f32 v98, v68, v69
    v_cvt_pk_bf16_f32 v99, v70, v71
    v_exp_f32 v74, v74
    v_exp_f32 v75, v75
    v_exp_f32 v76, v76
    v_exp_f32 v77, v77
    v_cvt_pk_bf16_f32 v100, v72, v73
    v_cvt_pk_bf16_f32 v101, v74, v75
    v_mfma_f32_32x32x16_bf16 v[44:59], v[112:115], v[96:99], v[44:59]
    buffer_load_dwordx4 v1, s[36:39], s15 offen offset:2048 sc1 lds
    v_exp_f32 v78, v78
    v_exp_f32 v79, v79
    v_cvt_pk_bf16_f32 v102, v76, v77
    v_cvt_pk_bf16_f32 v103, v78, v79
    v_exp_f32 v80, v80
    v_exp_f32 v81, v81
    s_waitcnt lgkmcnt(0)
    v_mfma_f32_32x32x16_bf16 v[44:59], v[120:123], v[100:103], v[44:59]
    ds_read_b128 v[120:123], v4 offset:7168
    v_exp_f32 v82, v82
    v_exp_f32 v83, v83
    v_exp_f32 v84, v84
    v_cvt_pk_bf16_f32 v96, v80, v81
    v_cvt_pk_bf16_f32 v97, v82, v83
    v_exp_f32 v85, v85
    v_exp_f32 v86, v86
    v_mfma_f32_32x32x16_bf16 v[64:79], v[104:107], v[36:39], 0
    ds_read_b128 v[112:115], v4 offset:10240
    v_exp_f32 v87, v87
    v_exp_f32 v88, v88
    v_exp_f32 v89, v89
    v_mfma_f32_32x32x16_bf16 v[64:79], v[108:111], v[40:43], v[64:79]
    ds_read_b128 v[104:107], v4 offset:12288
    ds_read_b128 v[108:111], v4 offset:13312
    v_cvt_pk_bf16_f32 v98, v84, v85
    v_cvt_pk_bf16_f32 v99, v86, v87
    v_exp_f32 v90, v90
    v_exp_f32 v91, v91
    v_exp_f32 v92, v92
    v_exp_f32 v93, v93
    v_cvt_pk_bf16_f32 v100, v88, v89
    v_cvt_pk_bf16_f32 v101, v90, v91
    v_mfma_f32_32x32x16_bf16 v[44:59], v[116:119], v[96:99], v[44:59]
    buffer_load_dwordx4 v1, s[36:39], s15 offen offset:3072 sc1 lds
    s_add_u32 s15, s15, 16384
    v_exp_f32 v94, v94
    v_exp_f32 v95, v95
    v_cvt_pk_bf16_f32 v102, v92, v93
    v_cvt_pk_bf16_f32 v103, v94, v95
    v_exp_f32 v64, v64
    v_exp_f32 v65, v65
    s_waitcnt lgkmcnt(0)
    v_mfma_f32_32x32x16_bf16 v[44:59], v[120:123], v[100:103], v[44:59]
    ds_read_b128 v[120:123], v4 offset:11264
    v_exp_f32 v66, v66
    v_exp_f32 v67, v67
    v_exp_f32 v68, v68
    v_cvt_pk_bf16_f32 v96, v64, v65
    v_cvt_pk_bf16_f32 v97, v66, v67
    v_exp_f32 v69, v69
    v_exp_f32 v70, v70
    v_mfma_f32_32x32x16_bf16 v[80:95], v[104:107], v[36:39], 0
    ds_read_b128 v[116:119], v4 offset:14336
    v_exp_f32 v71, v71
    v_exp_f32 v72, v72
    v_exp_f32 v73, v73
    v_mfma_f32_32x32x16_bf16 v[80:95], v[108:111], v[40:43], v[80:95]
    s_waitcnt vmcnt(4)
    s_barrier
    ds_read_b128 v[104:107], v4 offset:32768
    ds_read_b128 v[108:111], v4 offset:33792
    s_add_u32 m0, s18, 32768
    v_cvt_pk_bf16_f32 v98, v68, v69
    v_cvt_pk_bf16_f32 v99, v70, v71
    v_exp_f32 v74, v74
    v_exp_f32 v75, v75
    v_exp_f32 v76, v76
    v_exp_f32 v77, v77
    v_cvt_pk_bf16_f32 v100, v72, v73
    v_cvt_pk_bf16_f32 v101, v74, v75
    v_mfma_f32_32x32x16_bf16 v[44:59], v[112:115], v[96:99], v[44:59]
    buffer_load_dwordx4 v1, s[36:39], s15 offen offset:0 sc1 lds
    v_exp_f32 v78, v78
    v_exp_f32 v79, v79
    v_cvt_pk_bf16_f32 v102, v76, v77
    v_cvt_pk_bf16_f32 v103, v78, v79
    v_exp_f32 v80, v80
    v_exp_f32 v81, v81
    s_waitcnt lgkmcnt(0)
    v_mfma_f32_32x32x16_bf16 v[44:59], v[120:123], v[100:103], v[44:59]
    ds_read_b128 v[120:123], v4 offset:15360
    v_exp_f32 v82, v82
    v_exp_f32 v83, v83
    v_exp_f32 v84, v84
    v_cvt_pk_bf16_f32 v96, v80, v81
    v_cvt_pk_bf16_f32 v97, v82, v83
    v_exp_f32 v85, v85
    v_exp_f32 v86, v86
    v_mfma_f32_32x32x16_bf16 v[64:79], v[104:107], v[36:39], 0
    ds_read_b128 v[112:115], v4 offset:34816
    v_exp_f32 v87, v87
    v_exp_f32 v88, v88
    v_exp_f32 v89, v89
    v_mfma_f32_32x32x16_bf16 v[64:79], v[108:111], v[40:43], v[64:79]
    ds_read_b128 v[104:107], v4 offset:36864
    ds_read_b128 v[108:111], v4 offset:37888
    v_cvt_pk_bf16_f32 v98, v84, v85
    v_cvt_pk_bf16_f32 v99, v86, v87
    v_exp_f32 v90, v90
    v_exp_f32 v91, v91
    v_exp_f32 v92, v92
    v_exp_f32 v93, v93
    v_cvt_pk_bf16_f32 v100, v88, v89
    v_cvt_pk_bf16_f32 v101, v90, v91
    v_mfma_f32_32x32x16_bf16 v[44:59], v[116:119], v[96:99], v[44:59]
    buffer_load_dwordx4 v1, s[36:39], s15 offen offset:1024 sc1 lds
    v_exp_f32 v94, v94
    v_exp_f32 v95, v95
    v_cvt_pk_bf16_f32 v102, v92, v93
    v_cvt_pk_bf16_f32 v103, v94, v95
    v_exp_f32 v64, v64
    v_exp_f32 v65, v65
    s_waitcnt lgkmcnt(0)
    v_mfma_f32_32x32x16_bf16 v[44:59], v[120:123], v[100:103], v[44:59]
    ds_read_b128 v[120:123], v4 offset:35840
    v_exp_f32 v66, v66
    v_exp_f32 v67, v67
    v_exp_f32 v68, v68
    v_cvt_pk_bf16_f32 v96, v64, v65
    v_cvt_pk_bf16_f32 v97, v66, v67
    v_exp_f32 v69, v69
    v_exp_f32 v70, v70
    v_mfma_f32_32x32x16_bf16 v[80:95], v[104:107], v[36:39], 0
    ds_read_b128 v[116:119], v4 offset:38912
    v_exp_f32 v71, v71
    v_exp_f32 v72, v72
    v_exp_f32 v73, v73
    v_mfma_f32_32x32x16_bf16 v[80:95], v[108:111], v[40:43], v[80:95]
    ds_read_b128 v[104:107], v4 offset:40960
    ds_read_b128 v[108:111], v4 offset:41984
    v_cvt_pk_bf16_f32 v98, v68, v69
    v_cvt_pk_bf16_f32 v99, v70, v71
    v_exp_f32 v74, v74
    v_exp_f32 v75, v75
    v_exp_f32 v76, v76
    v_exp_f32 v77, v77
    v_cvt_pk_bf16_f32 v100, v72, v73
    v_cvt_pk_bf16_f32 v101, v74, v75
    v_mfma_f32_32x32x16_bf16 v[44:59], v[112:115], v[96:99], v[44:59]
    buffer_load_dwordx4 v1, s[36:39], s15 offen offset:2048 sc1 lds
    v_exp_f32 v78, v78
    v_exp_f32 v79, v79
    v_cvt_pk_bf16_f32 v102, v76, v77
    v_cvt_pk_bf16_f32 v103, v78, v79
    v_exp_f32 v80, v80
    v_exp_f32 v81, v81
    s_waitcnt lgkmcnt(0)
    v_mfma_f32_32x32x16_bf16 v[44:59], v[120:123], v[100:103], v[44:59]
    ds_read_b128 v[120:123], v4 offset:39936
    v_exp_f32 v82, v82
    v_exp_f32 v83, v83
    v_exp_f32 v84, v84
    v_cvt_pk_bf16_f32 v96, v80, v81
    v_cvt_pk_bf16_f32 v97, v82, v83
    v_exp_f32 v85, v85
    v_exp_f32 v86, v86
    v_mfma_f32_32x32x16_bf16 v[64:79], v[104:107], v[36:39], 0
    ds_read_b128 v[112:115], v4 offset:43008
    v_exp_f32 v87, v87
    v_exp_f32 v88, v88
    v_exp_f32 v89, v89
    v_mfma_f32_32x32x16_bf16 v[64:79], v[108:111], v[40:43], v[64:79]
    ds_read_b128 v[104:107], v4 offset:45056
    ds_read_b128 v[108:111], v4 offset:46080
    v_cvt_pk_bf16_f32 v98, v84, v85
    v_cvt_pk_bf16_f32 v99, v86, v87
    v_exp_f32 v90, v90
    v_exp_f32 v91, v91
    v_exp_f32 v92, v92
    v_exp_f32 v93, v93
    v_cvt_pk_bf16_f32 v100, v88, v89
    v_cvt_pk_bf16_f32 v101, v90, v91
    v_mfma_f32_32x32x16_bf16 v[44:59], v[116:119], v[96:99], v[44:59]
    buffer_load_dwordx4 v1, s[36:39], s15 offen offset:3072 sc1 lds
    s_add_u32 s15, s15, 16384
    v_exp_f32 v94, v94
    v_exp_f32 v95, v95
    v_cvt_pk_bf16_f32 v102, v92, v93
    v_cvt_pk_bf16_f32 v103, v94, v95
    v_exp_f32 v64, v64
    v_exp_f32 v65, v65
    s_waitcnt lgkmcnt(0)
    v_mfma_f32_32x32x16_bf16 v[44:59], v[120:123], v[100:103], v[44:59]
    ds_read_b128 v[120:123], v4 offset:44032
    v_exp_f32 v66, v66
    v_exp_f32 v67, v67
    v_exp_f32 v68, v68
    v_cvt_pk_bf16_f32 v96, v64, v65
    v_cvt_pk_bf16_f32 v97, v66, v67
    v_exp_f32 v69, v69
    v_exp_f32 v70, v70
    v_mfma_f32_32x32x16_bf16 v[80:95], v[104:107], v[36:39], 0
    ds_read_b128 v[116:119], v4 offset:47104
    v_exp_f32 v71, v71
    v_exp_f32 v72, v72
    v_exp_f32 v73, v73
    v_mfma_f32_32x32x16_bf16 v[80:95], v[108:111], v[40:43], v[80:95]
    s_waitcnt vmcnt(4)
    s_barrier
    ds_read_b128 v[104:107], v3 offset:0
    ds_read_b128 v[108:111], v3 offset:1024
    s_add_u32 m0, s18, 65536
    v_cvt_pk_bf16_f32 v98, v68, v69
    v_cvt_pk_bf16_f32 v99, v70, v71
    v_exp_f32 v74, v74
    v_exp_f32 v75, v75
    v_exp_f32 v76, v76
    v_exp_f32 v77, v77
    v_cvt_pk_bf16_f32 v100, v72, v73
    v_cvt_pk_bf16_f32 v101, v74, v75
    v_mfma_f32_32x32x16_bf16 v[44:59], v[112:115], v[96:99], v[44:59]
    buffer_load_dwordx4 v1, s[36:39], s15 offen offset:0 sc1 lds
    v_exp_f32 v78, v78
    v_exp_f32 v79, v79
    v_cvt_pk_bf16_f32 v102, v76, v77
    v_cvt_pk_bf16_f32 v103, v78, v79
    v_exp_f32 v80, v80
    v_exp_f32 v81, v81
    s_waitcnt lgkmcnt(0)
    v_mfma_f32_32x32x16_bf16 v[44:59], v[120:123], v[100:103], v[44:59]
    ds_read_b128 v[120:123], v4 offset:48128
    v_exp_f32 v82, v82
    v_exp_f32 v83, v83
    v_exp_f32 v84, v84
    v_cvt_pk_bf16_f32 v96, v80, v81
    v_cvt_pk_bf16_f32 v97, v82, v83
    v_exp_f32 v85, v85
    v_exp_f32 v86, v86
    v_mfma_f32_32x32x16_bf16 v[64:79], v[104:107], v[36:39], 0
    ds_read_b128 v[112:115], v3 offset:2048
    v_exp_f32 v87, v87
    v_exp_f32 v88, v88
    v_exp_f32 v89, v89
    v_mfma_f32_32x32x16_bf16 v[64:79], v[108:111], v[40:43], v[64:79]
    ds_read_b128 v[104:107], v3 offset:4096
    ds_read_b128 v[108:111], v3 offset:5120
    v_cvt_pk_bf16_f32 v98, v84, v85
    v_cvt_pk_bf16_f32 v99, v86, v87
    v_exp_f32 v90, v90
    v_exp_f32 v91, v91
    v_exp_f32 v92, v92
    v_exp_f32 v93, v93
    v_cvt_pk_bf16_f32 v100, v88, v89
    v_cvt_pk_bf16_f32 v101, v90, v91
    v_mfma_f32_32x32x16_bf16 v[44:59], v[116:119], v[96:99], v[44:59]
    buffer_load_dwordx4 v1, s[36:39], s15 offen offset:1024 sc1 lds
    v_exp_f32 v94, v94
    v_exp_f32 v95, v95
    v_cvt_pk_bf16_f32 v102, v92, v93
    v_cvt_pk_bf16_f32 v103, v94, v95
    v_exp_f32 v64, v64
    v_exp_f32 v65, v65
    s_waitcnt lgkmcnt(0)
    v_mfma_f32_32x32x16_bf16 v[44:59], v[120:123], v[100:103], v[44:59]
    ds_read_b128 v[120:123], v3 offset:3072
    v_exp_f32 v66, v66
    v_exp_f32 v67, v67
    v_exp_f32 v68, v68
    v_cvt_pk_bf16_f32 v96, v64, v65
    v_cvt_pk_bf16_f32 v97, v66, v67
    v_exp_f32 v69, v69
    v_exp_f32 v70, v70
    v_mfma_f32_32x32x16_bf16 v[80:95], v[104:107], v[36:39], 0
    ds_read_b128 v[116:119], v3 offset:6144
    v_exp_f32 v71, v71
    v_exp_f32 v72, v72
    v_exp_f32 v73, v73
    v_mfma_f32_32x32x16_bf16 v[80:95], v[108:111], v[40:43], v[80:95]
    ds_read_b128 v[104:107], v3 offset:8192
    ds_read_b128 v[108:111], v3 offset:9216
    v_cvt_pk_bf16_f32 v98, v68, v69
    v_cvt_pk_bf16_f32 v99, v70, v71
    v_exp_f32 v74, v74
    v_exp_f32 v75, v75
    v_exp_f32 v76, v76
    v_exp_f32 v77, v77
    v_cvt_pk_bf16_f32 v100, v72, v73
    v_cvt_pk_bf16_f32 v101, v74, v75
    v_mfma_f32_32x32x16_bf16 v[44:59], v[112:115], v[96:99], v[44:59]
    buffer_load_dwordx4 v1, s[36:39], s15 offen offset:2048 sc1 lds
    v_exp_f32 v78, v78
    v_exp_f32 v79, v79
    v_cvt_pk_bf16_f32 v102, v76, v77
    v_cvt_pk_bf16_f32 v103, v78, v79
    v_exp_f32 v80, v80
    v_exp_f32 v81, v81
    s_waitcnt lgkmcnt(0)
    v_mfma_f32_32x32x16_bf16 v[44:59], v[120:123], v[100:103], v[44:59]
    ds_read_b128 v[120:123], v3 offset:7168
    v_exp_f32 v82, v82
    v_exp_f32 v83, v83
    v_exp_f32 v84, v84
    v_cvt_pk_bf16_f32 v96, v80, v81
    v_cvt_pk_bf16_f32 v97, v82, v83
    v_exp_f32 v85, v85
    v_exp_f32 v86, v86
    v_mfma_f32_32x32x16_bf16 v[64:79], v[104:107], v[36:39], 0
    ds_read_b128 v[112:115], v3 offset:10240
    v_exp_f32 v87, v87
    v_exp_f32 v88, v88
    v_exp_f32 v89, v89
    v_mfma_f32_32x32x16_bf16 v[64:79], v[108:111], v[40:43], v[64:79]
    ds_read_b128 v[104:107], v3 offset:12288
    ds_read_b128 v[108:111], v3 offset:13312
    v_cvt_pk_bf16_f32 v98, v84, v85
    v_cvt_pk_bf16_f32 v99, v86, v87
    v_exp_f32 v90, v90
    v_exp_f32 v91, v91
    v_exp_f32 v92, v92
    v_exp_f32 v93, v93
    v_cvt_pk_bf16_f32 v100, v88, v89
    v_cvt_pk_bf16_f32 v101, v90, v91
    v_mfma_f32_32x32x16_bf16 v[44:59], v[116:119], v[96:99], v[44:59]
    buffer_load_dwordx4 v1, s[36:39], s15 offen offset:3072 sc1 lds
    s_add_u32 s15, s15, 16384
    v_exp_f32 v94, v94
    v_exp_f32 v95, v95
    v_cvt_pk_bf16_f32 v102, v92, v93
    v_cvt_pk_bf16_f32 v103, v94, v95
    v_exp_f32 v64, v64
    v_exp_f32 v65, v65
    s_waitcnt lgkmcnt(0)
    v_mfma_f32_32x32x16_bf16 v[44:59], v[120:123], v[100:103], v[44:59]
    ds_read_b128 v[120:123], v3 offset:11264
    v_exp_f32 v66, v66
    v_exp_f32 v67, v67
    v_exp_f32 v68, v68
    v_cvt_pk_bf16_f32 v96, v64, v65
    v_cvt_pk_bf16_f32 v97, v66, v67
    v_exp_f32 v69, v69
    v_exp_f32 v70, v70
    v_mfma_f32_32x32x16_bf16 v[80:95], v[104:107], v[36:39], 0
    ds_read_b128 v[116:119], v3 offset:14336
    v_exp_f32 v71, v71
    v_exp_f32 v72, v72
    v_exp_f32 v73, v73
    v_mfma_f32_32x32x16_bf16 v[80:95], v[108:111], v[40:43], v[80:95]
    s_waitcnt vmcnt(4)
    s_barrier
    ds_read_b128 v[104:107], v3 offset:32768
    ds_read_b128 v[108:111], v3 offset:33792
    v_cvt_pk_bf16_f32 v98, v68, v69
    v_cvt_pk_bf16_f32 v99, v70, v71
    v_exp_f32 v74, v74
    v_exp_f32 v75, v75
    v_exp_f32 v76, v76
    v_exp_f32 v77, v77
    v_cvt_pk_bf16_f32 v100, v72, v73
    v_cvt_pk_bf16_f32 v101, v74, v75
    v_mfma_f32_32x32x16_bf16 v[44:59], v[112:115], v[96:99], v[44:59]
    v_exp_f32 v78, v78
    v_exp_f32 v79, v79
    v_cvt_pk_bf16_f32 v102, v76, v77
    v_cvt_pk_bf16_f32 v103, v78, v79
    v_exp_f32 v80, v80
    v_exp_f32 v81, v81
    s_waitcnt lgkmcnt(0)
    v_mfma_f32_32x32x16_bf16 v[44:59], v[120:123], v[100:103], v[44:59]
    ds_read_b128 v[120:123], v3 offset:15360
    v_exp_f32 v82, v82
    v_exp_f32 v83, v83
    v_exp_f32 v84, v84
    v_cvt_pk_bf16_f32 v96, v80, v81
    v_cvt_pk_bf16_f32 v97, v82, v83
    v_exp_f32 v85, v85
    v_exp_f32 v86, v86
    v_mfma_f32_32x32x16_bf16 v[64:79], v[104:107], v[36:39], 0
    ds_read_b128 v[112:115], v3 offset:34816
    v_exp_f32 v87, v87
    v_exp_f32 v88, v88
    v_exp_f32 v89, v89
    v_mfma_f32_32x32x16_bf16 v[64:79], v[108:111], v[40:43], v[64:79]
    ds_read_b128 v[104:107], v3 offset:36864
    ds_read_b128 v[108:111], v3 offset:37888
    v_cvt_pk_bf16_f32 v98, v84, v85
    v_cvt_pk_bf16_f32 v99, v86, v87
    v_exp_f32 v90, v90
    v_exp_f32 v91, v91
    v_exp_f32 v92, v92
    v_exp_f32 v93, v93
    v_cvt_pk_bf16_f32 v100, v88, v89
    v_cvt_pk_bf16_f32 v101, v90, v91
    v_mfma_f32_32x32x16_bf16 v[44:59], v[116:119], v[96:99], v[44:59]
    v_exp_f32 v94, v94
    v_exp_f32 v95, v95
    v_cvt_pk_bf16_f32 v102, v92, v93
    v_cvt_pk_bf16_f32 v103, v94, v95
    v_exp_f32 v64, v64
    v_exp_f32 v65, v65
    s_waitcnt lgkmcnt(0)
    v_mfma_f32_32x32x16_bf16 v[44:59], v[120:123], v[100:103], v[44:59]
    ds_read_b128 v[120:123], v3 offset:35840
    v_exp_f32 v66, v66
    v_exp_f32 v67, v67
    v_exp_f32 v68, v68
    v_cvt_pk_bf16_f32 v96, v64, v65
    v_cvt_pk_bf16_f32 v97, v66, v67
    v_exp_f32 v69, v69
    v_exp_f32 v70, v70
    v_mfma_f32_32x32x16_bf16 v[80:95], v[104:107], v[36:39], 0
    ds_read_b128 v[116:119], v3 offset:38912
    v_exp_f32 v71, v71
    v_exp_f32 v72, v72
    v_exp_f32 v73, v73
    v_mfma_f32_32x32x16_bf16 v[80:95], v[108:111], v[40:43], v[80:95]
    ds_read_b128 v[104:107], v3 offset:40960
    ds_read_b128 v[108:111], v3 offset:41984
    v_cvt_pk_bf16_f32 v98, v68, v69
    v_cvt_pk_bf16_f32 v99, v70, v71
    v_exp_f32 v74, v74
    v_exp_f32 v75, v75
    v_exp_f32 v76, v76
    v_exp_f32 v77, v77
    v_cvt_pk_bf16_f32 v100, v72, v73
    v_cvt_pk_bf16_f32 v101, v74, v75
    v_mfma_f32_32x32x16_bf16 v[44:59], v[112:115], v[96:99], v[44:59]
    v_exp_f32 v78, v78
    v_exp_f32 v79, v79
    v_cvt_pk_bf16_f32 v102, v76, v77
    v_cvt_pk_bf16_f32 v103, v78, v79
    v_exp_f32 v80, v80
    v_exp_f32 v81, v81
    s_waitcnt lgkmcnt(0)
    v_mfma_f32_32x32x16_bf16 v[44:59], v[120:123], v[100:103], v[44:59]
    ds_read_b128 v[120:123], v3 offset:39936
    v_exp_f32 v82, v82
    v_exp_f32 v83, v83
    v_exp_f32 v84, v84
    v_cvt_pk_bf16_f32 v96, v80, v81
    v_cvt_pk_bf16_f32 v97, v82, v83
    v_exp_f32 v85, v85
    v_exp_f32 v86, v86
    v_mfma_f32_32x32x16_bf16 v[64:79], v[104:107], v[36:39], 0
    ds_read_b128 v[112:115], v3 offset:43008
    v_exp_f32 v87, v87
    v_exp_f32 v88, v88
    v_exp_f32 v89, v89
    v_mfma_f32_32x32x16_bf16 v[64:79], v[108:111], v[40:43], v[64:79]
    ds_read_b128 v[104:107], v3 offset:45056
    ds_read_b128 v[108:111], v3 offset:46080
    v_cvt_pk_bf16_f32 v98, v84, v85
    v_cvt_pk_bf16_f32 v99, v86, v87
    v_exp_f32 v90, v90
    v_exp_f32 v91, v91
    v_exp_f32 v92, v92
    v_exp_f32 v93, v93
    v_cvt_pk_bf16_f32 v100, v88, v89
    v_cvt_pk_bf16_f32 v101, v90, v91
    v_mfma_f32_32x32x16_bf16 v[44:59], v[116:119], v[96:99], v[44:59]
    v_exp_f32 v94, v94
    v_exp_f32 v95, v95
    v_cvt_pk_bf16_f32 v102, v92, v93
    v_cvt_pk_bf16_f32 v103, v94, v95
    v_exp_f32 v64, v64
    v_exp_f32 v65, v65
    s_waitcnt lgkmcnt(0)
    v_mfma_f32_32x32x16_bf16 v[44:59], v[120:123], v[100:103], v[44:59]
    ds_read_b128 v[120:123], v3 offset:44032
    v_exp_f32 v66, v66
    v_exp_f32 v67, v67
    v_exp_f32 v68, v68
    v_cvt_pk_bf16_f32 v96, v64, v65
    v_cvt_pk_bf16_f32 v97, v66, v67
    v_exp_f32 v69, v69
    v_exp_f32 v70, v70
    v_mfma_f32_32x32x16_bf16 v[80:95], v[104:107], v[36:39], 0
    ds_read_b128 v[116:119], v3 offset:47104
    v_exp_f32 v71, v71
    v_exp_f32 v72, v72
    v_exp_f32 v73, v73
    v_mfma_f32_32x32x16_bf16 v[80:95], v[108:111], v[40:43], v[80:95]
    s_waitcnt vmcnt(0)
    s_barrier
    ds_read_b128 v[104:107], v4 offset:0
    ds_read_b128 v[108:111], v4 offset:1024
    v_cvt_pk_bf16_f32 v98, v68, v69
    v_cvt_pk_bf16_f32 v99, v70, v71
    v_exp_f32 v74, v74
    v_exp_f32 v75, v75
    v_exp_f32 v76, v76
    v_exp_f32 v77, v77
    v_cvt_pk_bf16_f32 v100, v72, v73
    v_cvt_pk_bf16_f32 v101, v74, v75
    v_mfma_f32_32x32x16_bf16 v[44:59], v[112:115], v[96:99], v[44:59]
    v_exp_f32 v78, v78
    v_exp_f32 v79, v79
    v_cvt_pk_bf16_f32 v102, v76, v77
    v_cvt_pk_bf16_f32 v103, v78, v79
    v_exp_f32 v80, v80
    v_exp_f32 v81, v81
    s_waitcnt lgkmcnt(0)
    v_mfma_f32_32x32x16_bf16 v[44:59], v[120:123], v[100:103], v[44:59]
    ds_read_b128 v[120:123], v3 offset:48128
    v_exp_f32 v82, v82
    v_exp_f32 v83, v83
    v_exp_f32 v84, v84
    v_cvt_pk_bf16_f32 v96, v80, v81
    v_cvt_pk_bf16_f32 v97, v82, v83
    v_exp_f32 v85, v85
    v_exp_f32 v86, v86
    v_mfma_f32_32x32x16_bf16 v[64:79], v[104:107], v[36:39], 0
    ds_read_b128 v[112:115], v4 offset:2048
    v_exp_f32 v87, v87
    v_exp_f32 v88, v88
    v_exp_f32 v89, v89
    v_mfma_f32_32x32x16_bf16 v[64:79], v[108:111], v[40:43], v[64:79]
    ds_read_b128 v[104:107], v4 offset:4096
    ds_read_b128 v[108:111], v4 offset:5120
    v_cvt_pk_bf16_f32 v98, v84, v85
    v_cvt_pk_bf16_f32 v99, v86, v87
    v_exp_f32 v90, v90
    v_exp_f32 v91, v91
    v_exp_f32 v92, v92
    v_exp_f32 v93, v93
    v_cvt_pk_bf16_f32 v100, v88, v89
    v_cvt_pk_bf16_f32 v101, v90, v91
    v_mfma_f32_32x32x16_bf16 v[44:59], v[116:119], v[96:99], v[44:59]
    v_exp_f32 v94, v94
    v_exp_f32 v95, v95
    v_cvt_pk_bf16_f32 v102, v92, v93
    v_cvt_pk_bf16_f32 v103, v94, v95
    v_exp_f32 v64, v64
    v_exp_f32 v65, v65
    s_waitcnt lgkmcnt(0)
    v_mfma_f32_32x32x16_bf16 v[44:59], v[120:123], v[100:103], v[44:59]
    ds_read_b128 v[120:123], v4 offset:3072
    v_exp_f32 v66, v66
    v_exp_f32 v67, v67
    v_exp_f32 v68, v68
    v_cvt_pk_bf16_f32 v96, v64, v65
    v_cvt_pk_bf16_f32 v97, v66, v67
    v_exp_f32 v69, v69
    v_exp_f32 v70, v70
    v_mfma_f32_32x32x16_bf16 v[80:95], v[104:107], v[36:39], 0
    ds_read_b128 v[116:119], v4 offset:6144
    v_exp_f32 v71, v71
    v_exp_f32 v72, v72
    v_exp_f32 v73, v73
    v_mfma_f32_32x32x16_bf16 v[80:95], v[108:111], v[40:43], v[80:95]
    ds_read_b128 v[104:107], v4 offset:8192
    ds_read_b128 v[108:111], v4 offset:9216
    v_cvt_pk_bf16_f32 v98, v68, v69
    v_cvt_pk_bf16_f32 v99, v70, v71
    v_exp_f32 v74, v74
    v_exp_f32 v75, v75
    v_exp_f32 v76, v76
    v_exp_f32 v77, v77
    v_cvt_pk_bf16_f32 v100, v72, v73
    v_cvt_pk_bf16_f32 v101, v74, v75
    v_mfma_f32_32x32x16_bf16 v[44:59], v[112:115], v[96:99], v[44:59]
    v_exp_f32 v78, v78
    v_exp_f32 v79, v79
    v_cvt_pk_bf16_f32 v102, v76, v77
    v_cvt_pk_bf16_f32 v103, v78, v79
    v_exp_f32 v80, v80
    v_exp_f32 v81, v81
    s_waitcnt lgkmcnt(0)
    v_mfma_f32_32x32x16_bf16 v[44:59], v[120:123], v[100:103], v[44:59]
    ds_read_b128 v[120:123], v4 offset:7168
    v_exp_f32 v82, v82
    v_exp_f32 v83, v83
    v_exp_f32 v84, v84
    v_cvt_pk_bf16_f32 v96, v80, v81
    v_cvt_pk_bf16_f32 v97, v82, v83
    v_exp_f32 v85, v85
    v_exp_f32 v86, v86
    v_mfma_f32_32x32x16_bf16 v[64:79], v[104:107], v[36:39], 0
    ds_read_b128 v[112:115], v4 offset:10240
    v_exp_f32 v87, v87
    v_exp_f32 v88, v88
    v_exp_f32 v89, v89
    v_mfma_f32_32x32x16_bf16 v[64:79], v[108:111], v[40:43], v[64:79]
    ds_read_b128 v[104:107], v4 offset:12288
    ds_read_b128 v[108:111], v4 offset:13312
    v_cvt_pk_bf16_f32 v98, v84, v85
    v_cvt_pk_bf16_f32 v99, v86, v87
    v_exp_f32 v90, v90
    v_exp_f32 v91, v91
    v_exp_f32 v92, v92
    v_exp_f32 v93, v93
    v_cvt_pk_bf16_f32 v100, v88, v89
    v_cvt_pk_bf16_f32 v101, v90, v91
    v_mfma_f32_32x32x16_bf16 v[44:59], v[116:119], v[96:99], v[44:59]
    s_lshl_b32 s6, s3, 11
    s_add_u32 s6, s6, 131072
    v_add_u32 v240, s6, v1
    v_xor_b32 v241, 8192, v240
    s_lshl_b32 s6, s3, 8
    s_add_u32 s6, s6, 147456
    v_lshl_add_u32 v242, v0, 2, s6
    v_or_b32 v243, 32, v0
    s_lshl_b32 s6, s52, 8
    s_add_u32 s6, s6, 147456
    v_lshl_add_u32 v243, v243, 2, s6
    s_mov_b32 s68, 528482304
    s_mov_b32 s69, 1602224128
    s_lshl_b32 s6, s4, 9
    s_add_u32 s6, s6, s5
    s_lshl_b32 s6, s6, 2
    s_add_u32 s6, s6, 13873152
    v_lshl_add_u32 v6, v0, 7, s6
    v_mov_b32 v7, s58
    v_exp_f32 v94, v94
    v_exp_f32 v95, v95
    v_cvt_pk_bf16_f32 v102, v92, v93
    v_cvt_pk_bf16_f32 v103, v94, v95
    v_exp_f32 v64, v64
    v_exp_f32 v65, v65
    s_waitcnt lgkmcnt(0)
    v_mfma_f32_32x32x16_bf16 v[44:59], v[120:123], v[100:103], v[44:59]
    ds_read_b128 v[120:123], v4 offset:11264
    v_exp_f32 v66, v66
    v_exp_f32 v67, v67
    v_exp_f32 v68, v68
    v_cvt_pk_bf16_f32 v96, v64, v65
    v_cvt_pk_bf16_f32 v97, v66, v67
    v_exp_f32 v69, v69
    v_exp_f32 v70, v70
    v_mfma_f32_32x32x16_bf16 v[80:95], v[104:107], v[36:39], 0
    ds_read_b128 v[116:119], v4 offset:14336
    v_exp_f32 v71, v71
    v_exp_f32 v72, v72
    v_exp_f32 v73, v73
    v_mfma_f32_32x32x16_bf16 v[80:95], v[108:111], v[40:43], v[80:95]
    v_cvt_pk_bf16_f32 v98, v68, v69
    v_cvt_pk_bf16_f32 v99, v70, v71
    v_exp_f32 v74, v74
    v_exp_f32 v75, v75
    v_exp_f32 v76, v76
    v_exp_f32 v77, v77
    v_cvt_pk_bf16_f32 v100, v72, v73
    v_cvt_pk_bf16_f32 v101, v74, v75
    v_mfma_f32_32x32x16_bf16 v[44:59], v[112:115], v[96:99], v[44:59]
    v_exp_f32 v78, v78
    v_exp_f32 v79, v79
    v_cvt_pk_bf16_f32 v102, v76, v77
    v_cvt_pk_bf16_f32 v103, v78, v79
    s_nop 1
    v_exp_f32 v80, v80
    v_exp_f32 v81, v81
    s_waitcnt lgkmcnt(0)
    v_mfma_f32_32x32x16_bf16 v[44:59], v[120:123], v[100:103], v[44:59]
    ds_read_b128 v[120:123], v4 offset:15360
    v_exp_f32 v82, v82
    v_exp_f32 v83, v83
    v_exp_f32 v84, v84
    v_cvt_pk_bf16_f32 v96, v80, v81
    v_cvt_pk_bf16_f32 v97, v82, v83
    v_exp_f32 v85, v85
    v_exp_f32 v86, v86
    v_exp_f32 v87, v87
    v_exp_f32 v88, v88
    v_exp_f32 v89, v89
    v_cvt_pk_bf16_f32 v98, v84, v85
    v_cvt_pk_bf16_f32 v99, v86, v87
    v_exp_f32 v90, v90
    v_exp_f32 v91, v91
    v_exp_f32 v92, v92
    v_exp_f32 v93, v93
    v_cvt_pk_bf16_f32 v100, v88, v89
    v_cvt_pk_bf16_f32 v101, v90, v91
    v_mfma_f32_32x32x16_bf16 v[44:59], v[116:119], v[96:99], v[44:59]
    v_exp_f32 v94, v94
    v_exp_f32 v95, v95
    v_cvt_pk_bf16_f32 v102, v92, v93
    v_cvt_pk_bf16_f32 v103, v94, v95
    s_nop 1
    s_waitcnt lgkmcnt(0)
    s_nop 0
    v_mfma_f32_32x32x16_bf16 v[44:59], v[120:123], v[100:103], v[44:59]
    s_cmp_eq_u32 s53, 0
    s_nop 10
    ds_write_b32 v242, v56
    s_cbranch_scc0 chi_37
    ds_write_b128 v240, v[52:55]
    ds_write_b128 v240, v[56:59] offset:1024
    s_branch cjn_38
chi_37:
    ds_write_b128 v240, v[44:47]
    ds_write_b128 v240, v[48:51] offset:1024
    s_waitcnt lgkmcnt(0)
    v_mov_b32 v44, v52
    v_mov_b32 v45, v53
    v_mov_b32 v46, v54
    v_mov_b32 v47, v55
    v_mov_b32 v48, v56
    v_mov_b32 v49, v57
    v_mov_b32 v50, v58
    v_mov_b32 v51, v59
cjn_38:
    s_waitcnt lgkmcnt(0)
    s_barrier
    ds_read2st64_b32 v[96:97], v243 offset0:0 offset1:4
    ds_read_b128 v[64:67], v241
    ds_read_b128 v[68:71], v241 offset:1024
    s_mov_b32 s66, 0
    s_sub_u32 s67, 0, s53
    s_waitcnt lgkmcnt(2)
    v_add_f32 v96, v96, v97
    v_rcp_f32 v97, v96
    v_cmp_nle_f32 vcc, s68, v96
    v_cmp_nge_f32 s[70:71], s69, v96
    s_waitcnt lgkmcnt(0)
    v_add_f32 v64, v64, v44
    v_add_f32 v65, v65, v45
    v_add_f32 v66, v66, v46
    v_add_f32 v67, v67, v47
    v_add_f32 v68, v68, v48
    v_add_f32 v69, v69, v49
    v_add_f32 v70, v70, v50
    v_add_f32 v71, v71, v51
    s_or_b64 s[70:71], s[70:71], vcc
    v_mul_f32 v64, v64, v97
    v_mul_f32 v65, v65, v97
    v_mul_f32 v66, v66, v97
    v_mul_f32 v67, v67, v97
    v_mul_f32 v68, v68, v97
    v_mul_f32 v69, v69, v97
    v_mul_f32 v70, v70, v97
    v_mul_f32 v71, v71, v97
    v_cvt_pk_bf16_f32 v104, v64, v65
    v_cvt_pk_bf16_f32 v105, v66, v67
    v_cvt_pk_bf16_f32 v106, v68, v69
    v_cvt_pk_bf16_f32 v107, v70, v71
    v_cndmask_b32 v106, v106, 0, s[66:67]
    v_cndmask_b32 v107, v107, 0, s[66:67]
    buffer_store_dwordx4 v[104:107], v1, s[36:39], s22 offen sc1
    v_add_f32 v98, |v64|, |v65|
    v_add_f32 v99, |v66|, |v67|
    v_add_f32 v100, |v68|, |v69|
    v_add_f32 v101, |v70|, |v71|
    v_add_f32 v98, v98, v99
    v_add_f32 v100, v100, v101
    s_mov_b32 s6, 0x7f7fffff
    v_add_f32 v98, v98, v100
    v_cmp_nge_f32 vcc, s6, v98
    s_nop 1
    s_or_b64 vcc, vcc, s[70:71]
    s_cbranch_vccnz cfb_39
cbk_40:
    s_cmp_eq_u32 s3, 0
    s_cselect_b64 vcc, -1, 0
    s_waitcnt vmcnt(0)
    s_barrier
    s_cbranch_vccz os_41
    s_mov_b64 exec, 0xffff
    buffer_store_dword v7, v6, s[36:39], 0 offen sc1
    s_mov_b64 exec, -1
os_41:
    s_cmp_eq_u32 s4, 0
    s_cbranch_scc0 C_noF_done
    s_cmp_eq_u32 s5, 7
    s_cbranch_scc0 C_noF_done
    s_cmp_eq_u32 s3, 0
    s_cbranch_scc0 C_noF_done
    v_lshrrev_b32 v240, 4, v0
    v_and_b32 v241, 15, v0
    v_lshlrev_b32 v240, 7, v240
    v_lshl_add_u32 v240, v241, 2, v240
    v_add_u32 v240, 13862912, v240
    buffer_load_dword v241, v240, s[36:39], 0 offen sc1
    s_cmp_eq_u32 s3, 0
    s_cbranch_scc0 pok_42
    s_waitcnt vmcnt(0)
    v_cmp_ne_u32 vcc, s58, v241
    s_cbranch_vccz pok_42
    s_mov_b32 s74, 2097152
psp_43:
    s_sleep 4
    buffer_load_dword v241, v240, s[36:39], 0 offen sc1
    s_sub_u32 s74, s74, 1
    s_waitcnt vmcnt(0)
    v_cmp_ne_u32 vcc, s58, v241
    s_cmp_eq_u32 s74, 0
    s_cbranch_scc1 pok_42
    s_cbranch_vccnz psp_43
pok_42:
    v_lshrrev_b32 v240, 4, v0
    v_and_b32 v241, 15, v0
    v_lshlrev_b32 v240, 7, v240
    v_lshl_add_u32 v240, v241, 2, v240
    v_add_u32 v240, 13863424, v240
    buffer_load_dword v241, v240, s[36:39], 0 offen sc1
    s_cmp_eq_u32 s3, 0
    s_cbranch_scc0 pok_44
    s_waitcnt vmcnt(0)
    v_cmp_ne_u32 vcc, s58, v241
    s_cbranch_vccz pok_44
    s_mov_b32 s74, 2097152
psp_45:
    s_sleep 4
    buffer_load_dword v241, v240, s[36:39], 0 offen sc1
    s_sub_u32 s74, s74, 1
    s_waitcnt vmcnt(0)
    v_cmp_ne_u32 vcc, s58, v241
    s_cmp_eq_u32 s74, 0
    s_cbranch_scc1 pok_44
    s_cbranch_vccnz psp_45
pok_44:
    v_lshrrev_b32 v240, 4, v0
    v_and_b32 v241, 15, v0
    v_lshlrev_b32 v240, 7, v240
    v_lshl_add_u32 v240, v241, 2, v240
    v_add_u32 v240, 13863936, v240
    buffer_load_dword v241, v240, s[36:39], 0 offen sc1
    s_cmp_eq_u32 s3, 0
    s_cbranch_scc0 pok_46
    s_waitcnt vmcnt(0)
    v_cmp_ne_u32 vcc, s58, v241
    s_cbranch_vccz pok_46
    s_mov_b32 s74, 2097152
psp_47:
    s_sleep 4
    buffer_load_dword v241, v240, s[36:39], 0 offen sc1
    s_sub_u32 s74, s74, 1
    s_waitcnt vmcnt(0)
    v_cmp_ne_u32 vcc, s58, v241
    s_cmp_eq_u32 s74, 0
    s_cbranch_scc1 pok_46
    s_cbranch_vccnz psp_47
pok_46:
    v_lshrrev_b32 v240, 4, v0
    v_and_b32 v241, 15, v0
    v_lshlrev_b32 v240, 7, v240
    v_lshl_add_u32 v240, v241, 2, v240
    v_add_u32 v240, 13864448, v240
    buffer_load_dword v241, v240, s[36:39], 0 offen sc1
    s_cmp_eq_u32 s3, 0
    s_cbranch_scc0 pok_48
    s_waitcnt vmcnt(0)
    v_cmp_ne_u32 vcc, s58, v241
    s_cbranch_vccz pok_48
    s_mov_b32 s74, 2097152
psp_49:
    s_sleep 4
    buffer_load_dword v241, v240, s[36:39], 0 offen sc1
    s_sub_u32 s74, s74, 1
    s_waitcnt vmcnt(0)
    v_cmp_ne_u32 vcc, s58, v241
    s_cmp_eq_u32 s74, 0
    s_cbranch_scc1 pok_48
    s_cbranch_vccnz psp_49
pok_48:
    v_mov_b32 v240, 13867008
    v_mov_b32 v241, s58
    s_mov_b64 exec, 1
    buffer_store_dword v241, v240, s[36:39], 0 offen sc1
    s_mov_b64 exec, -1
C_noF_done:
K_fin:
    s_endpgm
cfb_29:
    s_mov_b32 s6, 13598720
    v_mov_b32 v103, 0xff800000
fb1_50:
    buffer_load_dwordx4 v[104:107], v1, s[36:39], s6 offen sc1
    buffer_load_dwordx4 v[108:111], v1, s[36:39], s6 offen offset:1024 sc1
    s_add_u32 s6, s6, 4096
    s_waitcnt vmcnt(0)
    v_mfma_f32_32x32x16_bf16 v[64:79], v[104:107], v[36:39], 0
    v_mfma_f32_32x32x16_bf16 v[64:79], v[108:111], v[40:43], v[64:79]
    s_nop 11
    v_max3_f32 v103, v103, v64, v65
    v_max3_f32 v103, v103, v66, v67
    v_max3_f32 v103, v103, v68, v69
    v_max3_f32 v103, v103, v70, v71
    v_max3_f32 v103, v103, v72, v73
    v_max3_f32 v103, v103, v74, v75
    v_max3_f32 v103, v103, v76, v77
    v_max3_f32 v103, v103, v78, v79
    s_cmp_lt_u32 s6, 13860864
    s_cbranch_scc1 fb1_50
    v_mov_b32 v96, v103
    s_nop 1
    v_permlane32_swap_b32 v96, v103
    v_max_f32 v103, v103, v96
    v_cvt_pk_bf16_f32 v96, v103, v103
    v_and_b32 v96, s49, v96
    v_sub_f32 v97, v103, v96
    v_cvt_pk_bf16_f32 v98, v97, v97
    v_and_b32 v98, s49, v98
    v_sub_f32 v97, v97, v98
    v_cvt_pk_bf16_f32 v96, -v96, -v98
    v_cvt_pk_bf16_f32 v97, -v97, 0
    v_cndmask_b32 v42, v42, v96, s[64:65]
    v_cndmask_b32 v43, v43, v97, s[64:65]
    s_mov_b32 s6, 13598720
    v_mov_b32 v44, 0
    v_mov_b32 v45, 0
    v_mov_b32 v46, 0
    v_mov_b32 v47, 0
    v_mov_b32 v48, 0
    v_mov_b32 v49, 0
    v_mov_b32 v50, 0
    v_mov_b32 v51, 0
    v_mov_b32 v52, 0
    v_mov_b32 v53, 0
    v_mov_b32 v54, 0
    v_mov_b32 v55, 0
    v_mov_b32 v56, 0
    v_mov_b32 v57, 0
    v_mov_b32 v58, 0
    v_mov_b32 v59, 0
fb2_51:
    buffer_load_dwordx4 v[104:107], v1, s[36:39], s6 offen offset:0 sc1
    buffer_load_dwordx4 v[108:111], v1, s[36:39], s6 offen offset:1024 sc1
    buffer_load_dwordx4 v[112:115], v1, s[36:39], s6 offen offset:2048 sc1
    buffer_load_dwordx4 v[116:119], v1, s[36:39], s6 offen offset:3072 sc1
    s_add_u32 s6, s6, 4096
    s_waitcnt vmcnt(0)
    v_mfma_f32_32x32x16_bf16 v[64:79], v[104:107], v[36:39], 0
    v_mfma_f32_32x32x16_bf16 v[64:79], v[108:111], v[40:43], v[64:79]
    s_nop 11
    v_exp_f32 v64, v64
    v_exp_f32 v65, v65
    v_exp_f32 v66, v66
    v_exp_f32 v67, v67
    v_exp_f32 v68, v68
    v_exp_f32 v69, v69
    v_exp_f32 v70, v70
    v_exp_f32 v71, v71
    v_exp_f32 v72, v72
    v_exp_f32 v73, v73
    v_exp_f32 v74, v74
    v_exp_f32 v75, v75
    v_exp_f32 v76, v76
    v_exp_f32 v77, v77
    v_exp_f32 v78, v78
    v_exp_f32 v79, v79
    s_nop 0
    v_cvt_pk_bf16_f32 v96, v64, v65
    v_cvt_pk_bf16_f32 v97, v66, v67
    v_cvt_pk_bf16_f32 v98, v68, v69
    v_cvt_pk_bf16_f32 v99, v70, v71
    v_cvt_pk_bf16_f32 v100, v72, v73
    v_cvt_pk_bf16_f32 v101, v74, v75
    v_cvt_pk_bf16_f32 v102, v76, v77
    v_cvt_pk_bf16_f32 v103, v78, v79
    s_nop 1
    v_mfma_f32_32x32x16_bf16 v[44:59], v[112:115], v[96:99], v[44:59]
    v_mfma_f32_32x32x16_bf16 v[44:59], v[116:119], v[100:103], v[44:59]
    s_cmp_lt_u32 s6, 13860864
    s_cbranch_scc1 fb2_51
    s_nop 11
    v_mov_b32 v96, v56
    v_mov_b32 v97, v56
    s_cmp_eq_u32 s53, 0
    s_nop 0
    v_permlane32_swap_b32 v96, v97
    v_rcp_f32 v97, v97
    s_cbranch_scc1 fb3_52
    v_mov_b32 v44, v52
    v_mov_b32 v45, v53
    v_mov_b32 v46, v54
    v_mov_b32 v47, v55
    v_mov_b32 v48, v56
    v_mov_b32 v49, v57
    v_mov_b32 v50, v58
    v_mov_b32 v51, v59
fb3_52:
    s_nop 0
    v_mul_f32 v64, v44, v97
    v_mul_f32 v65, v45, v97
    v_mul_f32 v66, v46, v97
    v_mul_f32 v67, v47, v97
    v_mul_f32 v68, v48, v97
    v_mul_f32 v69, v49, v97
    v_mul_f32 v70, v50, v97
    v_mul_f32 v71, v51, v97
    v_cvt_pk_bf16_f32 v104, v64, v65
    v_cvt_pk_bf16_f32 v105, v66, v67
    v_cvt_pk_bf16_f32 v106, v68, v69
    v_cvt_pk_bf16_f32 v107, v70, v71
    v_cndmask_b32 v106, v106, 0, s[66:67]
    v_cndmask_b32 v107, v107, 0, s[66:67]
    buffer_store_dwordx4 v[104:107], v1, s[36:39], s22 offen sc1
    s_waitcnt vmcnt(0)
    s_branch cbk_30
cfb_39:
    s_mov_b32 s6, 13598720
    v_mov_b32 v103, 0xff800000
fb1_53:
    buffer_load_dwordx4 v[104:107], v1, s[36:39], s6 offen sc1
    buffer_load_dwordx4 v[108:111], v1, s[36:39], s6 offen offset:1024 sc1
    s_add_u32 s6, s6, 4096
    s_waitcnt vmcnt(0)
    v_mfma_f32_32x32x16_bf16 v[64:79], v[104:107], v[36:39], 0
    v_mfma_f32_32x32x16_bf16 v[64:79], v[108:111], v[40:43], v[64:79]
    s_nop 11
    v_max3_f32 v103, v103, v64, v65
    v_max3_f32 v103, v103, v66, v67
    v_max3_f32 v103, v103, v68, v69
    v_max3_f32 v103, v103, v70, v71
    v_max3_f32 v103, v103, v72, v73
    v_max3_f32 v103, v103, v74, v75
    v_max3_f32 v103, v103, v76, v77
    v_max3_f32 v103, v103, v78, v79
    s_cmp_lt_u32 s6, 13860864
    s_cbranch_scc1 fb1_53
    v_mov_b32 v96, v103
    s_nop 1
    v_permlane32_swap_b32 v96, v103
    v_max_f32 v103, v103, v96
    v_cvt_pk_bf16_f32 v96, v103, v103
    v_and_b32 v96, s49, v96
    v_sub_f32 v97, v103, v96
    v_cvt_pk_bf16_f32 v98, v97, v97
    v_and_b32 v98, s49, v98
    v_sub_f32 v97, v97, v98
    v_cvt_pk_bf16_f32 v96, -v96, -v98
    v_cvt_pk_bf16_f32 v97, -v97, 0
    v_cndmask_b32 v42, v42, v96, s[64:65]
    v_cndmask_b32 v43, v43, v97, s[64:65]
    s_mov_b32 s6, 13598720
    v_mov_b32 v44, 0
    v_mov_b32 v45, 0
    v_mov_b32 v46, 0
    v_mov_b32 v47, 0
    v_mov_b32 v48, 0
    v_mov_b32 v49, 0
    v_mov_b32 v50, 0
    v_mov_b32 v51, 0
    v_mov_b32 v52, 0
    v_mov_b32 v53, 0
    v_mov_b32 v54, 0
    v_mov_b32 v55, 0
    v_mov_b32 v56, 0
    v_mov_b32 v57, 0
    v_mov_b32 v58, 0
    v_mov_b32 v59, 0
fb2_54:
    buffer_load_dwordx4 v[104:107], v1, s[36:39], s6 offen offset:0 sc1
    buffer_load_dwordx4 v[108:111], v1, s[36:39], s6 offen offset:1024 sc1
    buffer_load_dwordx4 v[112:115], v1, s[36:39], s6 offen offset:2048 sc1
    buffer_load_dwordx4 v[116:119], v1, s[36:39], s6 offen offset:3072 sc1
    s_add_u32 s6, s6, 4096
    s_waitcnt vmcnt(0)
    v_mfma_f32_32x32x16_bf16 v[64:79], v[104:107], v[36:39], 0
    v_mfma_f32_32x32x16_bf16 v[64:79], v[108:111], v[40:43], v[64:79]
    s_nop 11
    v_exp_f32 v64, v64
    v_exp_f32 v65, v65
    v_exp_f32 v66, v66
    v_exp_f32 v67, v67
    v_exp_f32 v68, v68
    v_exp_f32 v69, v69
    v_exp_f32 v70, v70
    v_exp_f32 v71, v71
    v_exp_f32 v72, v72
    v_exp_f32 v73, v73
    v_exp_f32 v74, v74
    v_exp_f32 v75, v75
    v_exp_f32 v76, v76
    v_exp_f32 v77, v77
    v_exp_f32 v78, v78
    v_exp_f32 v79, v79
    s_nop 0
    v_cvt_pk_bf16_f32 v96, v64, v65
    v_cvt_pk_bf16_f32 v97, v66, v67
    v_cvt_pk_bf16_f32 v98, v68, v69
    v_cvt_pk_bf16_f32 v99, v70, v71
    v_cvt_pk_bf16_f32 v100, v72, v73
    v_cvt_pk_bf16_f32 v101, v74, v75
    v_cvt_pk_bf16_f32 v102, v76, v77
    v_cvt_pk_bf16_f32 v103, v78, v79
    s_nop 1
    v_mfma_f32_32x32x16_bf16 v[44:59], v[112:115], v[96:99], v[44:59]
    v_mfma_f32_32x32x16_bf16 v[44:59], v[116:119], v[100:103], v[44:59]
    s_cmp_lt_u32 s6, 13860864
    s_cbranch_scc1 fb2_54
    s_nop 11
    v_mov_b32 v96, v56
    v_mov_b32 v97, v56
    s_cmp_eq_u32 s53, 0
    s_nop 0
    v_permlane32_swap_b32 v96, v97
    v_rcp_f32 v97, v97
    s_cbranch_scc1 fb3_55
    v_mov_b32 v44, v52
    v_mov_b32 v45, v53
    v_mov_b32 v46, v54
    v_mov_b32 v47, v55
    v_mov_b32 v48, v56
    v_mov_b32 v49, v57
    v_mov_b32 v50, v58
    v_mov_b32 v51, v59
fb3_55:
    s_nop 0
    v_mul_f32 v64, v44, v97
    v_mul_f32 v65, v45, v97
    v_mul_f32 v66, v46, v97
    v_mul_f32 v67, v47, v97
    v_mul_f32 v68, v48, v97
    v_mul_f32 v69, v49, v97
    v_mul_f32 v70, v50, v97
    v_mul_f32 v71, v51, v97
    v_cvt_pk_bf16_f32 v104, v64, v65
    v_cvt_pk_bf16_f32 v105, v66, v67
    v_cvt_pk_bf16_f32 v106, v68, v69
    v_cvt_pk_bf16_f32 v107, v70, v71
    v_cndmask_b32 v106, v106, 0, s[66:67]
    v_cndmask_b32 v107, v107, 0, s[66:67]
    buffer_store_dwordx4 v[104:107], v1, s[36:39], s22 offen sc1
    s_waitcnt vmcnt(0)
    s_branch cbk_40
K_end:
    s_endpgm
.section .rodata,"a"
.p2align 6
.amdhsa_kernel parallel_sum__grouped_kv_mqa__glu_gated_geglu__prompt_kernel
  .amdhsa_next_free_vgpr 256
  .amdhsa_next_free_sgpr 102
  .amdhsa_accum_offset 256
  .amdhsa_group_segment_fixed_size 0
  .amdhsa_kernarg_size 96
  .amdhsa_user_sgpr_count 2
  .amdhsa_user_sgpr_kernarg_segment_ptr 1
  .amdhsa_system_sgpr_workgroup_id_x 1
  .amdhsa_float_denorm_mode_32 3
.end_amdhsa_kernel
```
